```python
import torch

def _softmax(x, axis=-1):
    return torch.softmax(x, dim=axis)
def _gelu(x):
    return torch.nn.functional.gelu(x, approximate="tanh")
def _silu(x):
    return torch.nn.functional.silu(x)
def _sigmoid(x):
    return torch.sigmoid(x)
def _layernorm(x, axis=-1, eps=1e-5):
    m = x.mean(dim=axis, keepdim=True)
    v = x.var(dim=axis, keepdim=True, unbiased=False)
    return (x - m) / torch.sqrt(v + eps)
def _scatter_add(tgt, idx, src, axis=0):
    return tgt.clone().index_add_(axis, idx, src)
def _segment_sum(src, seg, n):
    out = torch.zeros((n,) + src.shape[1:], dtype=src.dtype)
    return out.index_add_(0, seg, src)
def _pad(x, pw):
    flat = tuple(v for pair in reversed(pw) for v in pair)
    return torch.nn.functional.pad(x, flat)

kernel_name = 'concat_heads__sliding_local_dilated__softmax_full_mha__prompt'

def setup_inputs():

    _w = (lambda a: (lambda t: t.to(torch.bfloat16) if t.is_floating_point() else t)(torch.as_tensor(a)))
    def _A_setup():
        B, S, D = 1, 2048, 512
        return {
            "x": _w((lambda *s: torch.randn(*s, dtype=torch.bfloat16) * 0.4)(B, S, D)),
            "wqkv": _w((lambda *s: torch.randn(*s, dtype=torch.bfloat16) * 0.4)(D, 3 * D)),
            "wo": _w((lambda *s: torch.randn(*s, dtype=torch.bfloat16) * 0.05)(D, D)),
        }
    _A_in = _A_setup()

    def _B_setup():
        B, S, D = 1, 2048, 512
        return {
            "x": _w((lambda *s: torch.randn(*s, dtype=torch.bfloat16) * 0.2)(B, S, D)),
            "wqkv": _w((lambda *s: torch.randn(*s, dtype=torch.bfloat16) * 0.4)(D, 3 * D)),
            "wo": _w((lambda *s: torch.randn(*s, dtype=torch.bfloat16) * 0.1)(D, D)),
        }
    _B_in = _B_setup()

    return {
        "A_x": _A_in["x"],
        "A_wqkv": _A_in["wqkv"],
        "A_wo": _A_in["wo"],
        "B_x": _B_in["x"],
        "B_wqkv": _B_in["wqkv"],
        "B_wo": _B_in["wo"],
    }

def reference(A_x, A_wqkv, A_wo, B_x, B_wqkv, B_wo):
    def _A_ref(x, wqkv, wo):
        B, S, D = x.shape
        H = 32; Dh = D // H
        W, dil = 8, 2
        qkv = (lambda x, *d: x.permute(*d))((x @ wqkv).reshape(B, S, 3, H, Dh), 2, 0, 3, 1, 4)
        q, k, v = qkv[0], qkv[1], qkv[2]
        scale = Dh ** -0.5
        pos = torch.arange(S)
        off = torch.arange(W) * dil
        idx = pos[:, None] - off[None, :]
        mask = idx >= 0
        idx_c = torch.where(mask, idx, 0).reshape(-1)
        kg = k[:, :, idx_c, :].reshape(B, H, S, W, Dh)
        vg = v[:, :, idx_c, :].reshape(B, H, S, W, Dh)
        logits = torch.einsum("bhsd,bhswd->bhsw", q, kg) * scale
        logits = torch.where(mask[None, None, :, :], logits, -1e9)
        attn = _softmax(logits, axis=-1)
        o = torch.einsum("bhsw,bhswd->bhsd", attn, vg)
        return (lambda x, *d: x.permute(*d))(o, 0, 2, 1, 3).reshape(B, S, D) @ wo

    def _B_ref(x, wqkv, wo):
        B, S, D = x.shape
        H = 32; Dh = D // H
        qkv = (lambda x, *d: x.permute(*d))((x @ wqkv).reshape(B, S, 3, H, Dh), 2, 0, 3, 1, 4)
        q, k, v = qkv[0], qkv[1], qkv[2]
        scale = Dh ** -0.5
        scores = torch.einsum("bhqd,bhkd->bhqk", q, k) * scale
        p = _softmax(scores, axis=-1)
        o = torch.einsum("bhqk,bhkd->bhqd", p, v)
        return (lambda x, *d: x.permute(*d))(o, 0, 2, 1, 3).reshape(B, S, D) @ wo

    a = _A_ref(A_x, A_wqkv, A_wo)
    b = _B_ref(B_x, B_wqkv, B_wo)
    return torch.concatenate([a, b], axis=-1)
```

```asm
; @launch grid=(256,1,1) block=(768,1,1) lds=163840
.amdgcn_target "amdgcn-amd-amdhsa--gfx950"
.text
.globl concat_heads__sliding_local_dilated__softmax_full_mha__prompt_kernel
.p2align 8
.type concat_heads__sliding_local_dilated__softmax_full_mha__prompt_kernel,@function
concat_heads__sliding_local_dilated__softmax_full_mha__prompt_kernel:
    s_cmp_ge_u32 s2, 256
    s_cbranch_scc1 L_exit
    s_load_dwordx16 s[64:79], s[0:1], 0
    s_load_dwordx2 s[80:81], s[0:1], 64
    v_lshrrev_b32 v2, 6, v0
    v_and_b32 v1, 63, v0
    s_and_b32 s4, s2, 7
    v_readfirstlane_b32 s3, v2
    s_lshr_b32 s5, s2, 3
    s_and_b32 s6, s4, 3
    s_lshl_b32 s6, s6, 3
    s_and_b32 s50, s5, 7
    s_add_u32 s6, s6, s50
    s_and_b32 s7, s4, 4
    s_lshr_b32 s50, s5, 3
    s_add_u32 s7, s7, s50
    s_lshl_b32 s50, s7, 1
    s_add_u32 s45, s6, s50
    s_and_b32 s45, s45, 7
    s_mov_b32 s46, 0xffff
    s_mov_b32 s47, 0xffff
    s_mov_b32 s48, 0xffff0000
    s_mov_b32 s49, 0xffff0000
    s_mov_b32 s10, 2097152
    s_mov_b32 s11, 0x20000
    s_mov_b32 s14, 1572864
    s_mov_b32 s15, 0x20000
    s_mov_b32 s18, 524288
    s_mov_b32 s19, 0x20000
    s_mov_b32 s22, 2097152
    s_mov_b32 s23, 0x20000
    s_mov_b32 s26, 1572864
    s_mov_b32 s27, 0x20000
    s_mov_b32 s30, 524288
    s_mov_b32 s31, 0x20000
    s_mov_b32 s34, 4194304
    s_mov_b32 s35, 0x20000
    s_mov_b32 s38, 256
    s_mov_b32 s39, 0x20000
    s_mov_b32 s42, 16777216
    s_mov_b32 s43, 0x20000
    s_cmp_lt_u32 s3, 4
    s_cbranch_scc1 L_g0_4
    s_cmp_ge_u32 s3, 8
    s_cbranch_scc1 L_g2_2
    s_sub_u32 s51, s3, 4
    v_lshrrev_b32 v14, 3, v1
    v_and_b32 v15, 7, v1
    v_lshlrev_b32 v16, 1, v14
    v_and_b32 v16, 4, v16
    v_xor_b32 v16, v15, v16
    v_lshlrev_b32 v16, 4, v16
    v_mul_u32_u24 v13, 3072, v14
    v_add_u32 v13, v13, v16
    s_and_b32 s50, s51, 1
    s_lshl_b32 s50, s50, 2
    v_lshrrev_b32 v16, 4, v1
    v_add_u32 v16, s50, v16
    v_xor_b32 v15, v15, v16
    v_lshlrev_b32 v15, 4, v15
    v_lshlrev_b32 v14, 10, v14
    v_add_u32 v12, v14, v15
    s_lshl_b32 s52, s51, 10
    s_lshl_b32 s53, s6, 16
    s_lshl_b32 s50, s51, 13
    s_add_u32 s53, s53, s50
    s_mul_i32 s54, s51, 24576
    s_lshl_b32 s55, s7, 7
    s_add_u32 s54, s54, s55
    s_mul_i32 s55, s51, 3072
    s_add_u32 s55, s55, 8192
    v_mov_b32 v17, 0
    s_waitcnt lgkmcnt(0)
    s_mov_b64 s[8:9], s[64:65]
    s_mov_b64 s[12:13], s[66:67]
    s_mov_b64 s[16:17], s[68:69]
    s_mov_b64 s[20:21], s[70:71]
    s_mov_b64 s[24:25], s[72:73]
    s_mov_b64 s[28:29], s[74:75]
    s_mov_b64 s[32:33], s[76:77]
    s_mov_b64 s[36:37], s[78:79]
    s_mov_b64 s[40:41], s[80:81]
    s_add_u32 s56, s45, 0
    s_and_b32 s56, s56, 7
    s_lshl_b32 s57, s56, 7
    s_add_u32 s57, s57, s53
    s_mul_i32 s56, s56, 196608
    s_add_u32 s56, s56, s54
    s_add_u32 m0, s52, 0
    s_add_u32 s58, s57, 0
    buffer_load_dwordx4 v12, s[20:23], s58 offen lds
    s_add_u32 m0, s52, 4096
    s_add_u32 s58, s57, 32768
    buffer_load_dwordx4 v12, s[20:23], s58 offen lds
    s_add_u32 m0, s55, 0
    s_add_u32 s58, s56, 0
    buffer_load_dwordx4 v13, s[24:27], s58 offen offset:0 lds
    buffer_load_dwordx4 v13, s[24:27], s58 offen offset:1024 lds
    buffer_load_dwordx4 v13, s[24:27], s58 offen offset:2048 lds
    s_add_u32 m0, s55, 12288
    s_add_u32 s58, s56, 98304
    buffer_load_dwordx4 v13, s[24:27], s58 offen offset:0 lds
    buffer_load_dwordx4 v13, s[24:27], s58 offen offset:1024 lds
    buffer_load_dwordx4 v13, s[24:27], s58 offen offset:2048 lds
    s_add_u32 s56, s45, 1
    s_and_b32 s56, s56, 7
    s_lshl_b32 s57, s56, 7
    s_add_u32 s57, s57, s53
    s_mul_i32 s56, s56, 196608
    s_add_u32 s56, s56, s54
    s_add_u32 m0, s52, 32768
    s_add_u32 s58, s57, 0
    buffer_load_dwordx4 v12, s[20:23], s58 offen lds
    s_add_u32 m0, s52, 36864
    s_add_u32 s58, s57, 32768
    buffer_load_dwordx4 v12, s[20:23], s58 offen lds
    s_add_u32 m0, s55, 32768
    s_add_u32 s58, s56, 0
    buffer_load_dwordx4 v13, s[24:27], s58 offen offset:0 lds
    buffer_load_dwordx4 v13, s[24:27], s58 offen offset:1024 lds
    buffer_load_dwordx4 v13, s[24:27], s58 offen offset:2048 lds
    s_add_u32 m0, s55, 45056
    s_add_u32 s58, s56, 98304
    buffer_load_dwordx4 v13, s[24:27], s58 offen offset:0 lds
    buffer_load_dwordx4 v13, s[24:27], s58 offen offset:1024 lds
    buffer_load_dwordx4 v13, s[24:27], s58 offen offset:2048 lds
    s_add_u32 s56, s45, 2
    s_and_b32 s56, s56, 7
    s_lshl_b32 s57, s56, 7
    s_add_u32 s57, s57, s53
    s_mul_i32 s56, s56, 196608
    s_add_u32 s56, s56, s54
    s_add_u32 m0, s52, 65536
    s_add_u32 s58, s57, 0
    buffer_load_dwordx4 v12, s[20:23], s58 offen lds
    s_add_u32 m0, s52, 69632
    s_add_u32 s58, s57, 32768
    buffer_load_dwordx4 v12, s[20:23], s58 offen lds
    s_add_u32 m0, s55, 65536
    s_add_u32 s58, s56, 0
    buffer_load_dwordx4 v13, s[24:27], s58 offen offset:0 lds
    buffer_load_dwordx4 v13, s[24:27], s58 offen offset:1024 lds
    buffer_load_dwordx4 v13, s[24:27], s58 offen offset:2048 lds
    s_add_u32 m0, s55, 77824
    s_add_u32 s58, s56, 98304
    buffer_load_dwordx4 v13, s[24:27], s58 offen offset:0 lds
    buffer_load_dwordx4 v13, s[24:27], s58 offen offset:1024 lds
    buffer_load_dwordx4 v13, s[24:27], s58 offen offset:2048 lds
    s_waitcnt vmcnt(16)
    s_barrier
    s_add_u32 s56, s45, 3
    s_and_b32 s56, s56, 7
    s_lshl_b32 s57, s56, 7
    s_add_u32 s57, s57, s53
    s_mul_i32 s56, s56, 196608
    s_add_u32 s56, s56, s54
    s_add_u32 m0, s52, 98304
    s_add_u32 s58, s57, 0
    buffer_load_dwordx4 v12, s[20:23], s58 offen lds
    s_add_u32 m0, s52, 102400
    s_add_u32 s58, s57, 32768
    buffer_load_dwordx4 v12, s[20:23], s58 offen lds
    s_add_u32 m0, s55, 98304
    s_add_u32 s58, s56, 0
    buffer_load_dwordx4 v13, s[24:27], s58 offen offset:0 lds
    buffer_load_dwordx4 v13, s[24:27], s58 offen offset:1024 lds
    buffer_load_dwordx4 v13, s[24:27], s58 offen offset:2048 lds
    s_add_u32 m0, s55, 110592
    s_add_u32 s58, s56, 98304
    buffer_load_dwordx4 v13, s[24:27], s58 offen offset:0 lds
    buffer_load_dwordx4 v13, s[24:27], s58 offen offset:1024 lds
    buffer_load_dwordx4 v13, s[24:27], s58 offen offset:2048 lds
    s_waitcnt vmcnt(16)
    s_barrier
    s_add_u32 s56, s45, 4
    s_and_b32 s56, s56, 7
    s_lshl_b32 s57, s56, 7
    s_add_u32 s57, s57, s53
    s_mul_i32 s56, s56, 196608
    s_add_u32 s56, s56, s54
    s_add_u32 m0, s52, 131072
    s_add_u32 s58, s57, 0
    buffer_load_dwordx4 v12, s[20:23], s58 offen lds
    s_add_u32 m0, s52, 135168
    s_add_u32 s58, s57, 32768
    buffer_load_dwordx4 v12, s[20:23], s58 offen lds
    s_add_u32 m0, s55, 131072
    s_add_u32 s58, s56, 0
    buffer_load_dwordx4 v13, s[24:27], s58 offen offset:0 lds
    buffer_load_dwordx4 v13, s[24:27], s58 offen offset:1024 lds
    buffer_load_dwordx4 v13, s[24:27], s58 offen offset:2048 lds
    s_add_u32 m0, s55, 143360
    s_add_u32 s58, s56, 98304
    buffer_load_dwordx4 v13, s[24:27], s58 offen offset:0 lds
    buffer_load_dwordx4 v13, s[24:27], s58 offen offset:1024 lds
    buffer_load_dwordx4 v13, s[24:27], s58 offen offset:2048 lds
    s_waitcnt vmcnt(16)
    s_barrier
    s_add_u32 s56, s45, 5
    s_and_b32 s56, s56, 7
    s_lshl_b32 s57, s56, 7
    s_add_u32 s57, s57, s53
    s_mul_i32 s56, s56, 196608
    s_add_u32 s56, s56, s54
    s_add_u32 m0, s52, 0
    s_add_u32 s58, s57, 0
    buffer_load_dwordx4 v12, s[20:23], s58 offen lds
    s_add_u32 m0, s52, 4096
    s_add_u32 s58, s57, 32768
    buffer_load_dwordx4 v12, s[20:23], s58 offen lds
    s_add_u32 m0, s55, 0
    s_add_u32 s58, s56, 0
    buffer_load_dwordx4 v13, s[24:27], s58 offen offset:0 lds
    buffer_load_dwordx4 v13, s[24:27], s58 offen offset:1024 lds
    buffer_load_dwordx4 v13, s[24:27], s58 offen offset:2048 lds
    s_add_u32 m0, s55, 12288
    s_add_u32 s58, s56, 98304
    buffer_load_dwordx4 v13, s[24:27], s58 offen offset:0 lds
    buffer_load_dwordx4 v13, s[24:27], s58 offen offset:1024 lds
    buffer_load_dwordx4 v13, s[24:27], s58 offen offset:2048 lds
    s_waitcnt vmcnt(16)
    s_barrier
    s_add_u32 s56, s45, 6
    s_and_b32 s56, s56, 7
    s_lshl_b32 s57, s56, 7
    s_add_u32 s57, s57, s53
    s_mul_i32 s56, s56, 196608
    s_add_u32 s56, s56, s54
    s_add_u32 m0, s52, 32768
    s_add_u32 s58, s57, 0
    buffer_load_dwordx4 v12, s[20:23], s58 offen lds
    s_add_u32 m0, s52, 36864
    s_add_u32 s58, s57, 32768
    buffer_load_dwordx4 v12, s[20:23], s58 offen lds
    s_add_u32 m0, s55, 32768
    s_add_u32 s58, s56, 0
    buffer_load_dwordx4 v13, s[24:27], s58 offen offset:0 lds
    buffer_load_dwordx4 v13, s[24:27], s58 offen offset:1024 lds
    buffer_load_dwordx4 v13, s[24:27], s58 offen offset:2048 lds
    s_add_u32 m0, s55, 45056
    s_add_u32 s58, s56, 98304
    buffer_load_dwordx4 v13, s[24:27], s58 offen offset:0 lds
    buffer_load_dwordx4 v13, s[24:27], s58 offen offset:1024 lds
    buffer_load_dwordx4 v13, s[24:27], s58 offen offset:2048 lds
    s_waitcnt vmcnt(16)
    s_barrier
    s_add_u32 s56, s45, 7
    s_and_b32 s56, s56, 7
    s_lshl_b32 s57, s56, 7
    s_add_u32 s57, s57, s53
    s_mul_i32 s56, s56, 196608
    s_add_u32 s56, s56, s54
    s_add_u32 m0, s52, 65536
    s_add_u32 s58, s57, 0
    buffer_load_dwordx4 v12, s[20:23], s58 offen lds
    s_add_u32 m0, s52, 69632
    s_add_u32 s58, s57, 32768
    buffer_load_dwordx4 v12, s[20:23], s58 offen lds
    s_add_u32 m0, s55, 65536
    s_add_u32 s58, s56, 0
    buffer_load_dwordx4 v13, s[24:27], s58 offen offset:0 lds
    buffer_load_dwordx4 v13, s[24:27], s58 offen offset:1024 lds
    buffer_load_dwordx4 v13, s[24:27], s58 offen offset:2048 lds
    s_add_u32 m0, s55, 77824
    s_add_u32 s58, s56, 98304
    buffer_load_dwordx4 v13, s[24:27], s58 offen offset:0 lds
    buffer_load_dwordx4 v13, s[24:27], s58 offen offset:1024 lds
    buffer_load_dwordx4 v13, s[24:27], s58 offen offset:2048 lds
    s_waitcnt vmcnt(16)
    s_barrier
    s_add_u32 s56, s45, 0
    s_and_b32 s56, s56, 7
    s_lshl_b32 s57, s56, 7
    s_add_u32 s57, s57, s53
    s_mul_i32 s56, s56, 196608
    s_add_u32 s56, s56, s54
    s_add_u32 m0, s52, 98304
    s_add_u32 s58, s57, 0
    buffer_load_dwordx4 v12, s[8:11], s58 offen lds
    s_add_u32 m0, s52, 102400
    s_add_u32 s58, s57, 32768
    buffer_load_dwordx4 v12, s[8:11], s58 offen lds
    s_add_u32 m0, s55, 98304
    s_add_u32 s58, s56, 0
    buffer_load_dwordx4 v13, s[12:15], s58 offen offset:0 lds
    buffer_load_dwordx4 v13, s[12:15], s58 offen offset:1024 lds
    buffer_load_dwordx4 v13, s[12:15], s58 offen offset:2048 lds
    s_add_u32 m0, s55, 110592
    s_add_u32 s58, s56, 98304
    buffer_load_dwordx4 v13, s[12:15], s58 offen offset:0 lds
    buffer_load_dwordx4 v13, s[12:15], s58 offen offset:1024 lds
    buffer_load_dwordx4 v13, s[12:15], s58 offen offset:2048 lds
    s_waitcnt vmcnt(16)
    s_barrier
    s_add_u32 s56, s45, 1
    s_and_b32 s56, s56, 7
    s_lshl_b32 s57, s56, 7
    s_add_u32 s57, s57, s53
    s_mul_i32 s56, s56, 196608
    s_add_u32 s56, s56, s54
    s_add_u32 m0, s52, 131072
    s_add_u32 s58, s57, 0
    buffer_load_dwordx4 v12, s[8:11], s58 offen lds
    s_add_u32 m0, s52, 135168
    s_add_u32 s58, s57, 32768
    buffer_load_dwordx4 v12, s[8:11], s58 offen lds
    s_add_u32 m0, s55, 131072
    s_add_u32 s58, s56, 0
    buffer_load_dwordx4 v13, s[12:15], s58 offen offset:0 lds
    buffer_load_dwordx4 v13, s[12:15], s58 offen offset:1024 lds
    buffer_load_dwordx4 v13, s[12:15], s58 offen offset:2048 lds
    s_add_u32 m0, s55, 143360
    s_add_u32 s58, s56, 98304
    buffer_load_dwordx4 v13, s[12:15], s58 offen offset:0 lds
    buffer_load_dwordx4 v13, s[12:15], s58 offen offset:1024 lds
    buffer_load_dwordx4 v13, s[12:15], s58 offen offset:2048 lds
    buffer_load_dword v16, v17, s[36:39], 0 offen sc1
    s_waitcnt vmcnt(17)
    s_barrier
    s_waitcnt vmcnt(9)
    s_barrier
    s_waitcnt vmcnt(1)
    s_barrier
    s_add_u32 s56, s45, 2
    s_and_b32 s56, s56, 7
    s_lshl_b32 s57, s56, 7
    s_add_u32 s57, s57, s53
    s_mul_i32 s56, s56, 196608
    s_add_u32 s56, s56, s54
    s_add_u32 m0, s52, 0
    s_add_u32 s58, s57, 0
    buffer_load_dwordx4 v12, s[8:11], s58 offen lds
    s_add_u32 m0, s52, 4096
    s_add_u32 s58, s57, 32768
    buffer_load_dwordx4 v12, s[8:11], s58 offen lds
    s_add_u32 m0, s55, 0
    s_add_u32 s58, s56, 0
    buffer_load_dwordx4 v13, s[12:15], s58 offen offset:0 lds
    buffer_load_dwordx4 v13, s[12:15], s58 offen offset:1024 lds
    buffer_load_dwordx4 v13, s[12:15], s58 offen offset:2048 lds
    s_add_u32 m0, s55, 12288
    s_add_u32 s58, s56, 98304
    buffer_load_dwordx4 v13, s[12:15], s58 offen offset:0 lds
    buffer_load_dwordx4 v13, s[12:15], s58 offen offset:1024 lds
    buffer_load_dwordx4 v13, s[12:15], s58 offen offset:2048 lds
    s_add_u32 s56, s45, 3
    s_and_b32 s56, s56, 7
    s_lshl_b32 s57, s56, 7
    s_add_u32 s57, s57, s53
    s_mul_i32 s56, s56, 196608
    s_add_u32 s56, s56, s54
    s_add_u32 m0, s52, 32768
    s_add_u32 s58, s57, 0
    buffer_load_dwordx4 v12, s[8:11], s58 offen lds
    s_add_u32 m0, s52, 36864
    s_add_u32 s58, s57, 32768
    buffer_load_dwordx4 v12, s[8:11], s58 offen lds
    s_add_u32 m0, s55, 32768
    s_add_u32 s58, s56, 0
    buffer_load_dwordx4 v13, s[12:15], s58 offen offset:0 lds
    buffer_load_dwordx4 v13, s[12:15], s58 offen offset:1024 lds
    buffer_load_dwordx4 v13, s[12:15], s58 offen offset:2048 lds
    s_add_u32 m0, s55, 45056
    s_add_u32 s58, s56, 98304
    buffer_load_dwordx4 v13, s[12:15], s58 offen offset:0 lds
    buffer_load_dwordx4 v13, s[12:15], s58 offen offset:1024 lds
    buffer_load_dwordx4 v13, s[12:15], s58 offen offset:2048 lds
    s_waitcnt vmcnt(8)
    s_barrier
    s_add_u32 s56, s45, 4
    s_and_b32 s56, s56, 7
    s_lshl_b32 s57, s56, 7
    s_add_u32 s57, s57, s53
    s_mul_i32 s56, s56, 196608
    s_add_u32 s56, s56, s54
    s_add_u32 m0, s52, 65536
    s_add_u32 s58, s57, 0
    buffer_load_dwordx4 v12, s[8:11], s58 offen lds
    s_add_u32 m0, s52, 69632
    s_add_u32 s58, s57, 32768
    buffer_load_dwordx4 v12, s[8:11], s58 offen lds
    s_add_u32 m0, s55, 65536
    s_add_u32 s58, s56, 0
    buffer_load_dwordx4 v13, s[12:15], s58 offen offset:0 lds
    buffer_load_dwordx4 v13, s[12:15], s58 offen offset:1024 lds
    buffer_load_dwordx4 v13, s[12:15], s58 offen offset:2048 lds
    s_add_u32 m0, s55, 77824
    s_add_u32 s58, s56, 98304
    buffer_load_dwordx4 v13, s[12:15], s58 offen offset:0 lds
    buffer_load_dwordx4 v13, s[12:15], s58 offen offset:1024 lds
    buffer_load_dwordx4 v13, s[12:15], s58 offen offset:2048 lds
    s_add_u32 s56, s45, 5
    s_and_b32 s56, s56, 7
    s_lshl_b32 s57, s56, 7
    s_add_u32 s57, s57, s53
    s_mul_i32 s56, s56, 196608
    s_add_u32 s56, s56, s54
    s_add_u32 m0, s52, 98304
    s_add_u32 s58, s57, 0
    buffer_load_dwordx4 v12, s[8:11], s58 offen lds
    s_add_u32 m0, s52, 102400
    s_add_u32 s58, s57, 32768
    buffer_load_dwordx4 v12, s[8:11], s58 offen lds
    s_add_u32 m0, s55, 98304
    s_add_u32 s58, s56, 0
    buffer_load_dwordx4 v13, s[12:15], s58 offen offset:0 lds
    buffer_load_dwordx4 v13, s[12:15], s58 offen offset:1024 lds
    buffer_load_dwordx4 v13, s[12:15], s58 offen offset:2048 lds
    s_add_u32 m0, s55, 110592
    s_add_u32 s58, s56, 98304
    buffer_load_dwordx4 v13, s[12:15], s58 offen offset:0 lds
    buffer_load_dwordx4 v13, s[12:15], s58 offen offset:1024 lds
    buffer_load_dwordx4 v13, s[12:15], s58 offen offset:2048 lds
    s_waitcnt vmcnt(16)
    s_barrier
    s_add_u32 s56, s45, 6
    s_and_b32 s56, s56, 7
    s_lshl_b32 s57, s56, 7
    s_add_u32 s57, s57, s53
    s_mul_i32 s56, s56, 196608
    s_add_u32 s56, s56, s54
    s_add_u32 m0, s52, 131072
    s_add_u32 s58, s57, 0
    buffer_load_dwordx4 v12, s[8:11], s58 offen lds
    s_add_u32 m0, s52, 135168
    s_add_u32 s58, s57, 32768
    buffer_load_dwordx4 v12, s[8:11], s58 offen lds
    s_add_u32 m0, s55, 131072
    s_add_u32 s58, s56, 0
    buffer_load_dwordx4 v13, s[12:15], s58 offen offset:0 lds
    buffer_load_dwordx4 v13, s[12:15], s58 offen offset:1024 lds
    buffer_load_dwordx4 v13, s[12:15], s58 offen offset:2048 lds
    s_add_u32 m0, s55, 143360
    s_add_u32 s58, s56, 98304
    buffer_load_dwordx4 v13, s[12:15], s58 offen offset:0 lds
    buffer_load_dwordx4 v13, s[12:15], s58 offen offset:1024 lds
    buffer_load_dwordx4 v13, s[12:15], s58 offen offset:2048 lds
    s_waitcnt vmcnt(16)
    s_barrier
    s_add_u32 s56, s45, 7
    s_and_b32 s56, s56, 7
    s_lshl_b32 s57, s56, 7
    s_add_u32 s57, s57, s53
    s_mul_i32 s56, s56, 196608
    s_add_u32 s56, s56, s54
    s_add_u32 m0, s52, 0
    s_add_u32 s58, s57, 0
    buffer_load_dwordx4 v12, s[8:11], s58 offen lds
    s_add_u32 m0, s52, 4096
    s_add_u32 s58, s57, 32768
    buffer_load_dwordx4 v12, s[8:11], s58 offen lds
    s_add_u32 m0, s55, 0
    s_add_u32 s58, s56, 0
    buffer_load_dwordx4 v13, s[12:15], s58 offen offset:0 lds
    buffer_load_dwordx4 v13, s[12:15], s58 offen offset:1024 lds
    buffer_load_dwordx4 v13, s[12:15], s58 offen offset:2048 lds
    s_add_u32 m0, s55, 12288
    s_add_u32 s58, s56, 98304
    buffer_load_dwordx4 v13, s[12:15], s58 offen offset:0 lds
    buffer_load_dwordx4 v13, s[12:15], s58 offen offset:1024 lds
    buffer_load_dwordx4 v13, s[12:15], s58 offen offset:2048 lds
    s_waitcnt vmcnt(16)
    s_barrier
    s_waitcnt vmcnt(8)
    s_barrier
    s_waitcnt vmcnt(0)
    s_barrier
    s_mov_b32 s50, 30000
L_gt_6:
    v_readfirstlane_b32 s44, v16
    s_nop 1
    s_cmp_lg_u32 s44, 0
    s_cbranch_scc1 L_gtd_7
    s_sleep 4
    buffer_load_dword v16, v17, s[36:39], 0 offen sc1
    s_sub_u32 s50, s50, 1
    s_cmp_lg_u32 s50, 0
    s_waitcnt vmcnt(0)
    s_cbranch_scc1 L_gt_6
L_gtd_7:
    s_lshl_b32 s58, s4, 2
    s_and_b32 s50, s5, 3
    s_add_u32 s58, s58, s50
    s_lshr_b32 s59, s5, 2
    s_lshl_b32 s59, s59, 3
    s_and_b32 s50, s3, 3
    s_lshl_b32 s50, s50, 1
    s_add_u32 s59, s59, s50
    s_lshr_b32 s60, s3, 2
    v_lshlrev_b32 v6, 4, v1
    v_lshrrev_b32 v7, 5, v1
    v_lshlrev_b32 v7, 8, v7
    v_and_b32 v9, 15, v1
    v_lshlrev_b32 v9, 4, v9
    v_add_u32 v7, v7, v9
    v_add_u32 v7, 33792, v7
    v_and_b32 v8, 3, v1
    v_lshlrev_b32 v8, 2, v8
    v_add_u32 v8, 30720, v8
    s_lshl_b32 s50, s60, 13
    v_add_u32 v15, 32768, v6
    v_add_u32 v13, s50, v15
    v_add_u32 v14, s50, v7
    v_add_u32 v92, 16384, v13
    v_add_u32 v93, 16384, v14
    v_mov_b32 v104, 0
    v_mov_b32 v105, 0
    v_mov_b32 v106, 0
    v_mov_b32 v107, 0
    v_mov_b32 v108, 0
    v_mov_b32 v109, 0
    v_mov_b32 v110, 0
    v_mov_b32 v111, 0
    v_mov_b32 v112, 0
    v_mov_b32 v113, 0
    v_mov_b32 v114, 0
    v_mov_b32 v115, 0
    v_mov_b32 v116, 0
    v_mov_b32 v117, 0
    v_mov_b32 v118, 0
    v_mov_b32 v119, 0
    s_mov_b32 exec_lo, 0x110000
    s_mov_b32 exec_hi, 0x110000
    v_mov_b32 v104, 0x3f803f80
    v_mov_b32 v105, 0x3f803f80
    v_mov_b32 v106, 0x3f803f80
    v_mov_b32 v107, 0x3f803f80
    v_mov_b32 v108, 0x3f803f80
    v_mov_b32 v109, 0x3f803f80
    v_mov_b32 v110, 0x3f803f80
    v_mov_b32 v111, 0x3f803f80
    v_mov_b32 v112, 0x3f803f80
    v_mov_b32 v113, 0x3f803f80
    v_mov_b32 v114, 0x3f803f80
    v_mov_b32 v115, 0x3f803f80
    v_mov_b32 v116, 0x3f803f80
    v_mov_b32 v117, 0x3f803f80
    v_mov_b32 v118, 0x3f803f80
    v_mov_b32 v119, 0x3f803f80
    s_mov_b64 exec, -1
    v_mov_b32 v32, 0
    v_mov_b32 v33, 0
    v_mov_b32 v34, 0
    v_mov_b32 v35, 0
    v_mov_b32 v36, 0
    v_mov_b32 v37, 0
    v_mov_b32 v38, 0
    v_mov_b32 v39, 0
    v_mov_b32 v40, 0
    v_mov_b32 v41, 0
    v_mov_b32 v42, 0
    v_mov_b32 v43, 0
    v_mov_b32 v44, 0
    v_mov_b32 v45, 0
    v_mov_b32 v46, 0
    v_mov_b32 v47, 0
    v_mov_b32 v140, 0
    v_mov_b32 v141, 0
    v_mov_b32 v142, 0
    v_mov_b32 v143, 0
    v_mov_b32 v144, 0
    v_mov_b32 v145, 0
    v_mov_b32 v146, 0
    v_mov_b32 v147, 0
    v_mov_b32 v148, 0
    v_mov_b32 v149, 0
    v_mov_b32 v150, 0
    v_mov_b32 v151, 0
    v_mov_b32 v152, 0
    v_mov_b32 v153, 0
    v_mov_b32 v154, 0
    v_mov_b32 v155, 0
    s_mov_b32 s63, 2
    v_mov_b32 v10, 65536
    s_mov_b32 s54, 4
L_qt_8:
    ds_read_b32 v11, v10
    s_waitcnt lgkmcnt(0)
    v_cmp_ne_u32 vcc, s44, v11
    s_nop 1
    s_cmp_eq_u64 vcc, 0
    s_cbranch_scc1 L_qtg_10
    s_sub_u32 s54, s54, 1
    s_cmp_lg_u32 s54, 0
    s_cbranch_scc1 L_qt_8
    s_branch L_qtd_9
L_qtg_10:
    s_lshl_b32 s56, s58, 16
    s_lshl_b32 s57, s59, 10
    s_add_u32 s56, s56, s57
    buffer_load_dwordx4 v[2:5], v6, s[40:43], s56 offen sc1
    buffer_load_dwordx4 v[120:123], v6, s[40:43], s56 offen offset:1024 sc1
    s_mov_b32 s63, 3
L_qtd_9:
    s_barrier
L_qwait_5:
    s_cmp_eq_u32 s63, 3
    s_cbranch_scc1 L_haveq_11
    v_mov_b32 v10, 30840
    s_mov_b32 s50, 0x80000
L_lw_12:
    ds_read_b32 v11, v10 offset:0
    s_waitcnt lgkmcnt(0)
    v_cmp_ne_u32 vcc, s44, v11
    s_nop 1
    s_cmp_eq_u64 vcc, 0
    s_cbranch_scc1 L_lwd_13
    s_sleep 1
    s_sub_u32 s50, s50, 1
    s_cmp_lg_u32 s50, 0
    s_cbranch_scc1 L_lw_12
L_lwd_13:
    s_lshl_b32 s56, s58, 16
    s_lshl_b32 s57, s59, 10
    s_add_u32 s56, s56, s57
    buffer_load_dwordx4 v[2:5], v6, s[40:43], s56 offen sc1
    buffer_load_dwordx4 v[120:123], v6, s[40:43], s56 offen offset:1024 sc1
L_haveq_11:
    v_mov_b32 v10, 30768
    s_mov_b32 s50, 0x80000
L_lw_14:
    ds_read_b32 v11, v10 offset:0
    s_waitcnt lgkmcnt(0)
    v_cmp_ne_u32 vcc, s44, v11
    s_nop 1
    s_cmp_eq_u64 vcc, 0
    s_cbranch_scc1 L_lwd_15
    s_sleep 1
    s_sub_u32 s50, s50, 1
    s_cmp_lg_u32 s50, 0
    s_cbranch_scc1 L_lw_14
L_lwd_15:
    s_branch L_att_3
L_g0_4:
    s_mov_b32 s51, s3
    s_and_b32 s52, s51, 1
    s_lshr_b32 s53, s51, 1
    v_and_b32 v2, 31, v1
    v_lshrrev_b32 v3, 5, v1
    v_and_b32 v4, 15, v1
    s_lshl_b32 s50, s52, 12
    v_lshlrev_b32 v5, 7, v2
    v_add_u32 v5, s50, v5
    v_lshrrev_b32 v7, 1, v4
    v_add_u32 v6, 0, v3
    v_xor_b32 v6, v6, v7
    v_lshlrev_b32 v6, 4, v6
    v_add_u32 v112, v5, v6
    v_add_u32 v116, 65536, v112
    v_add_u32 v120, 131072, v112
    v_add_u32 v6, 2, v3
    v_xor_b32 v6, v6, v7
    v_lshlrev_b32 v6, 4, v6
    v_add_u32 v113, v5, v6
    v_add_u32 v117, 65536, v113
    v_add_u32 v121, 131072, v113
    v_add_u32 v6, 4, v3
    v_xor_b32 v6, v6, v7
    v_lshlrev_b32 v6, 4, v6
    v_add_u32 v114, v5, v6
    v_add_u32 v118, 65536, v114
    v_add_u32 v122, 131072, v114
    v_add_u32 v6, 6, v3
    v_xor_b32 v6, v6, v7
    v_lshlrev_b32 v6, 4, v6
    v_add_u32 v115, v5, v6
    v_add_u32 v119, 65536, v115
    v_add_u32 v123, 131072, v115
    v_mul_u32_u24 v6, 3072, v3
    v_lshrrev_b32 v7, 2, v4
    v_lshlrev_b32 v8, 7, v7
    v_add_u32 v6, v6, v8
    v_lshrrev_b32 v7, 1, v7
    v_xor_b32 v7, s53, v7
    v_lshlrev_b32 v7, 6, v7
    v_add_u32 v6, v6, v7
    v_and_b32 v7, 16, v1
    v_lshlrev_b32 v7, 1, v7
    v_add_u32 v6, v6, v7
    v_and_b32 v7, 3, v1
    v_lshlrev_b32 v7, 3, v7
    v_add_u32 v6, v6, v7
    v_add_u32 v124, 8192, v6
    v_add_u32 v125, 73728, v6
    v_add_u32 v126, 139264, v6
    v_mov_b32 v10, 0
    s_lshl_b32 s54, s6, 1
    s_add_u32 s54, s54, s52
    s_lshl_b32 s55, s7, 2
    s_lshl_b32 s56, s53, 1
    s_add_u32 s55, s55, s56
    s_lshl_b32 s56, s55, 16
    s_lshl_b32 s57, s54, 10
    s_add_u32 s56, s56, s57
    s_add_u32 s57, s56, 65536
    s_lshl_b32 s58, s55, 17
    s_lshl_b32 s59, s54, 11
    s_add_u32 s58, s58, s59
    s_add_u32 s58, s58, 2097152
    s_add_u32 s59, s58, 131072
    v_lshlrev_b32 v2, 4, v1
    v_and_b32 v3, 16, v1
    v_lshlrev_b32 v3, 13, v3
    v_lshrrev_b32 v4, 5, v1
    v_lshlrev_b32 v4, 8, v4
    v_add_u32 v3, v3, v4
    v_and_b32 v4, 15, v1
    v_lshlrev_b32 v4, 4, v4
    v_add_u32 v3, v3, v4
    s_mov_b32 s60, 1052289595
    s_waitcnt lgkmcnt(0)
    s_mov_b64 s[8:9], s[64:65]
    s_mov_b64 s[12:13], s[66:67]
    s_mov_b64 s[16:17], s[68:69]
    s_mov_b64 s[20:21], s[70:71]
    s_mov_b64 s[24:25], s[72:73]
    s_mov_b64 s[28:29], s[74:75]
    s_mov_b64 s[32:33], s[76:77]
    s_mov_b64 s[36:37], s[78:79]
    s_mov_b64 s[40:41], s[80:81]
    s_or_b32 s50, s2, s3
    s_cmp_lg_u32 s50, 0
    s_cbranch_scc1 L_notag_16
    s_memrealtime s[62:63]
    s_waitcnt lgkmcnt(0)
    s_or_b32 s62, s62, 1
    v_mov_b32 v11, s62
    s_mov_b64 exec, 1
    buffer_store_dword v11, v10, s[36:39], 0 offen sc1
    s_mov_b64 exec, -1
L_notag_16:
    s_barrier
    ds_read_b128 v[64:67], v112 offset:0
    ds_read_b64_tr_b16 v[68:69], v124 offset:0
    ds_read_b64_tr_b16 v[70:71], v124 offset:512
    ds_read_b64_tr_b16 v[72:73], v124 offset:1024
    ds_read_b64_tr_b16 v[74:75], v124 offset:1536
    ds_read_b64_tr_b16 v[76:77], v124 offset:2048
    ds_read_b64_tr_b16 v[78:79], v124 offset:2560
    ds_read_b128 v[80:83], v113 offset:0
    ds_read_b64_tr_b16 v[84:85], v124 offset:6144
    ds_read_b64_tr_b16 v[86:87], v124 offset:6656
    ds_read_b64_tr_b16 v[88:89], v124 offset:7168
    ds_read_b64_tr_b16 v[90:91], v124 offset:7680
    ds_read_b64_tr_b16 v[92:93], v124 offset:8192
    ds_read_b64_tr_b16 v[94:95], v124 offset:8704
    s_waitcnt lgkmcnt(7)
    v_mfma_f32_32x32x16_bf16 v[32:47], v[72:75], v[64:67], 0
    ds_read_b128 v[96:99], v114 offset:0
    ds_read_b64_tr_b16 v[100:101], v124 offset:12288
    ds_read_b64_tr_b16 v[102:103], v124 offset:12800
    v_mfma_f32_32x32x16_bf16 v[48:63], v[64:67], v[76:79], 0
    ds_read_b64_tr_b16 v[104:105], v124 offset:13312
    ds_read_b64_tr_b16 v[106:107], v124 offset:13824
    v_mfma_f32_32x32x16_bf16 v[16:31], v[68:71], v[64:67], 0
    ds_read_b64_tr_b16 v[108:109], v124 offset:14336
    ds_read_b64_tr_b16 v[110:111], v124 offset:14848
    s_waitcnt lgkmcnt(7)
    v_mfma_f32_32x32x16_bf16 v[32:47], v[88:91], v[80:83], v[32:47]
    ds_read_b128 v[64:67], v115 offset:0
    ds_read_b64_tr_b16 v[68:69], v124 offset:18432
    ds_read_b64_tr_b16 v[70:71], v124 offset:18944
    v_mfma_f32_32x32x16_bf16 v[48:63], v[80:83], v[92:95], v[48:63]
    ds_read_b64_tr_b16 v[72:73], v124 offset:19456
    ds_read_b64_tr_b16 v[74:75], v124 offset:19968
    v_mfma_f32_32x32x16_bf16 v[16:31], v[84:87], v[80:83], v[16:31]
    ds_read_b64_tr_b16 v[76:77], v124 offset:20480
    ds_read_b64_tr_b16 v[78:79], v124 offset:20992
    s_waitcnt lgkmcnt(7)
    v_mfma_f32_32x32x16_bf16 v[32:47], v[104:107], v[96:99], v[32:47]
    s_barrier
    ds_read_b128 v[80:83], v112 offset:32768
    ds_read_b64_tr_b16 v[84:85], v124 offset:32768
    ds_read_b64_tr_b16 v[86:87], v124 offset:33280
    v_mfma_f32_32x32x16_bf16 v[48:63], v[96:99], v[108:111], v[48:63]
    ds_read_b64_tr_b16 v[88:89], v124 offset:33792
    ds_read_b64_tr_b16 v[90:91], v124 offset:34304
    v_mfma_f32_32x32x16_bf16 v[16:31], v[100:103], v[96:99], v[16:31]
    ds_read_b64_tr_b16 v[92:93], v124 offset:34816
    ds_read_b64_tr_b16 v[94:95], v124 offset:35328
    s_waitcnt lgkmcnt(7)
    v_mfma_f32_32x32x16_bf16 v[32:47], v[72:75], v[64:67], v[32:47]
    ds_read_b128 v[96:99], v113 offset:32768
    ds_read_b64_tr_b16 v[100:101], v124 offset:38912
    ds_read_b64_tr_b16 v[102:103], v124 offset:39424
    v_mfma_f32_32x32x16_bf16 v[48:63], v[64:67], v[76:79], v[48:63]
    ds_read_b64_tr_b16 v[104:105], v124 offset:39936
    ds_read_b64_tr_b16 v[106:107], v124 offset:40448
    v_mfma_f32_32x32x16_bf16 v[16:31], v[68:71], v[64:67], v[16:31]
    ds_read_b64_tr_b16 v[108:109], v124 offset:40960
    ds_read_b64_tr_b16 v[110:111], v124 offset:41472
    s_waitcnt lgkmcnt(7)
    v_mfma_f32_32x32x16_bf16 v[32:47], v[88:91], v[80:83], v[32:47]
    ds_read_b128 v[64:67], v114 offset:32768
    ds_read_b64_tr_b16 v[68:69], v124 offset:45056
    ds_read_b64_tr_b16 v[70:71], v124 offset:45568
    v_mfma_f32_32x32x16_bf16 v[48:63], v[80:83], v[92:95], v[48:63]
    ds_read_b64_tr_b16 v[72:73], v124 offset:46080
    ds_read_b64_tr_b16 v[74:75], v124 offset:46592
    v_mfma_f32_32x32x16_bf16 v[16:31], v[84:87], v[80:83], v[16:31]
    ds_read_b64_tr_b16 v[76:77], v124 offset:47104
    ds_read_b64_tr_b16 v[78:79], v124 offset:47616
    s_waitcnt lgkmcnt(7)
    v_mfma_f32_32x32x16_bf16 v[32:47], v[104:107], v[96:99], v[32:47]
    ds_read_b128 v[80:83], v115 offset:32768
    ds_read_b64_tr_b16 v[84:85], v124 offset:51200
    ds_read_b64_tr_b16 v[86:87], v124 offset:51712
    v_mfma_f32_32x32x16_bf16 v[48:63], v[96:99], v[108:111], v[48:63]
    ds_read_b64_tr_b16 v[88:89], v124 offset:52224
    ds_read_b64_tr_b16 v[90:91], v124 offset:52736
    v_mfma_f32_32x32x16_bf16 v[16:31], v[100:103], v[96:99], v[16:31]
    ds_read_b64_tr_b16 v[92:93], v124 offset:53248
    ds_read_b64_tr_b16 v[94:95], v124 offset:53760
    s_waitcnt lgkmcnt(7)
    v_mfma_f32_32x32x16_bf16 v[32:47], v[72:75], v[64:67], v[32:47]
    s_barrier
    ds_read_b128 v[96:99], v116 offset:0
    ds_read_b64_tr_b16 v[100:101], v125 offset:0
    ds_read_b64_tr_b16 v[102:103], v125 offset:512
    v_mfma_f32_32x32x16_bf16 v[48:63], v[64:67], v[76:79], v[48:63]
    ds_read_b64_tr_b16 v[104:105], v125 offset:1024
    ds_read_b64_tr_b16 v[106:107], v125 offset:1536
    v_mfma_f32_32x32x16_bf16 v[16:31], v[68:71], v[64:67], v[16:31]
    ds_read_b64_tr_b16 v[108:109], v125 offset:2048
    ds_read_b64_tr_b16 v[110:111], v125 offset:2560
    s_waitcnt lgkmcnt(7)
    v_mfma_f32_32x32x16_bf16 v[32:47], v[88:91], v[80:83], v[32:47]
    ds_read_b128 v[64:67], v117 offset:0
    ds_read_b64_tr_b16 v[68:69], v125 offset:6144
    ds_read_b64_tr_b16 v[70:71], v125 offset:6656
    v_mfma_f32_32x32x16_bf16 v[48:63], v[80:83], v[92:95], v[48:63]
    ds_read_b64_tr_b16 v[72:73], v125 offset:7168
    ds_read_b64_tr_b16 v[74:75], v125 offset:7680
    v_mfma_f32_32x32x16_bf16 v[16:31], v[84:87], v[80:83], v[16:31]
    ds_read_b64_tr_b16 v[76:77], v125 offset:8192
    ds_read_b64_tr_b16 v[78:79], v125 offset:8704
    s_waitcnt lgkmcnt(7)
    v_mfma_f32_32x32x16_bf16 v[32:47], v[104:107], v[96:99], v[32:47]
    ds_read_b128 v[80:83], v118 offset:0
    ds_read_b64_tr_b16 v[84:85], v125 offset:12288
    ds_read_b64_tr_b16 v[86:87], v125 offset:12800
    v_mfma_f32_32x32x16_bf16 v[48:63], v[96:99], v[108:111], v[48:63]
    ds_read_b64_tr_b16 v[88:89], v125 offset:13312
    ds_read_b64_tr_b16 v[90:91], v125 offset:13824
    v_mfma_f32_32x32x16_bf16 v[16:31], v[100:103], v[96:99], v[16:31]
    ds_read_b64_tr_b16 v[92:93], v125 offset:14336
    ds_read_b64_tr_b16 v[94:95], v125 offset:14848
    s_waitcnt lgkmcnt(7)
    v_mfma_f32_32x32x16_bf16 v[32:47], v[72:75], v[64:67], v[32:47]
    ds_read_b128 v[96:99], v119 offset:0
    ds_read_b64_tr_b16 v[100:101], v125 offset:18432
    ds_read_b64_tr_b16 v[102:103], v125 offset:18944
    v_mfma_f32_32x32x16_bf16 v[48:63], v[64:67], v[76:79], v[48:63]
    ds_read_b64_tr_b16 v[104:105], v125 offset:19456
    ds_read_b64_tr_b16 v[106:107], v125 offset:19968
    v_mfma_f32_32x32x16_bf16 v[16:31], v[68:71], v[64:67], v[16:31]
    ds_read_b64_tr_b16 v[108:109], v125 offset:20480
    ds_read_b64_tr_b16 v[110:111], v125 offset:20992
    s_waitcnt lgkmcnt(7)
    v_mfma_f32_32x32x16_bf16 v[32:47], v[88:91], v[80:83], v[32:47]
    s_barrier
    ds_read_b128 v[64:67], v116 offset:32768
    ds_read_b64_tr_b16 v[68:69], v125 offset:32768
    ds_read_b64_tr_b16 v[70:71], v125 offset:33280
    v_mfma_f32_32x32x16_bf16 v[48:63], v[80:83], v[92:95], v[48:63]
    ds_read_b64_tr_b16 v[72:73], v125 offset:33792
    ds_read_b64_tr_b16 v[74:75], v125 offset:34304
    v_mfma_f32_32x32x16_bf16 v[16:31], v[84:87], v[80:83], v[16:31]
    ds_read_b64_tr_b16 v[76:77], v125 offset:34816
    ds_read_b64_tr_b16 v[78:79], v125 offset:35328
    s_waitcnt lgkmcnt(7)
    v_mfma_f32_32x32x16_bf16 v[32:47], v[104:107], v[96:99], v[32:47]
    ds_read_b128 v[80:83], v117 offset:32768
    ds_read_b64_tr_b16 v[84:85], v125 offset:38912
    ds_read_b64_tr_b16 v[86:87], v125 offset:39424
    v_mfma_f32_32x32x16_bf16 v[48:63], v[96:99], v[108:111], v[48:63]
    ds_read_b64_tr_b16 v[88:89], v125 offset:39936
    ds_read_b64_tr_b16 v[90:91], v125 offset:40448
    v_mfma_f32_32x32x16_bf16 v[16:31], v[100:103], v[96:99], v[16:31]
    ds_read_b64_tr_b16 v[92:93], v125 offset:40960
    ds_read_b64_tr_b16 v[94:95], v125 offset:41472
    s_waitcnt lgkmcnt(7)
    v_mfma_f32_32x32x16_bf16 v[32:47], v[72:75], v[64:67], v[32:47]
    buffer_load_dword v9, v10, s[36:39], 0 offen sc1
    ds_read_b128 v[96:99], v118 offset:32768
    ds_read_b64_tr_b16 v[100:101], v125 offset:45056
    ds_read_b64_tr_b16 v[102:103], v125 offset:45568
    v_mfma_f32_32x32x16_bf16 v[48:63], v[64:67], v[76:79], v[48:63]
    ds_read_b64_tr_b16 v[104:105], v125 offset:46080
    ds_read_b64_tr_b16 v[106:107], v125 offset:46592
    v_mfma_f32_32x32x16_bf16 v[16:31], v[68:71], v[64:67], v[16:31]
    ds_read_b64_tr_b16 v[108:109], v125 offset:47104
    ds_read_b64_tr_b16 v[110:111], v125 offset:47616
    s_waitcnt lgkmcnt(7)
    v_mfma_f32_32x32x16_bf16 v[32:47], v[88:91], v[80:83], v[32:47]
    ds_read_b128 v[64:67], v119 offset:32768
    ds_read_b64_tr_b16 v[68:69], v125 offset:51200
    ds_read_b64_tr_b16 v[70:71], v125 offset:51712
    v_mfma_f32_32x32x16_bf16 v[48:63], v[80:83], v[92:95], v[48:63]
    ds_read_b64_tr_b16 v[72:73], v125 offset:52224
    ds_read_b64_tr_b16 v[74:75], v125 offset:52736
    v_mfma_f32_32x32x16_bf16 v[16:31], v[84:87], v[80:83], v[16:31]
    ds_read_b64_tr_b16 v[76:77], v125 offset:53248
    ds_read_b64_tr_b16 v[78:79], v125 offset:53760
    s_waitcnt lgkmcnt(7)
    v_mfma_f32_32x32x16_bf16 v[32:47], v[104:107], v[96:99], v[32:47]
    s_barrier
    ds_read_b128 v[80:83], v120 offset:0
    ds_read_b64_tr_b16 v[84:85], v126 offset:0
    ds_read_b64_tr_b16 v[86:87], v126 offset:512
    v_mfma_f32_32x32x16_bf16 v[48:63], v[96:99], v[108:111], v[48:63]
    ds_read_b64_tr_b16 v[88:89], v126 offset:1024
    ds_read_b64_tr_b16 v[90:91], v126 offset:1536
    v_mfma_f32_32x32x16_bf16 v[16:31], v[100:103], v[96:99], v[16:31]
    ds_read_b64_tr_b16 v[92:93], v126 offset:2048
    ds_read_b64_tr_b16 v[94:95], v126 offset:2560
    s_waitcnt lgkmcnt(7)
    v_mfma_f32_32x32x16_bf16 v[32:47], v[72:75], v[64:67], v[32:47]
    ds_read_b128 v[96:99], v121 offset:0
    ds_read_b64_tr_b16 v[100:101], v126 offset:6144
    ds_read_b64_tr_b16 v[102:103], v126 offset:6656
    v_mfma_f32_32x32x16_bf16 v[48:63], v[64:67], v[76:79], v[48:63]
    ds_read_b64_tr_b16 v[104:105], v126 offset:7168
    ds_read_b64_tr_b16 v[106:107], v126 offset:7680
    v_mfma_f32_32x32x16_bf16 v[16:31], v[68:71], v[64:67], v[16:31]
    ds_read_b64_tr_b16 v[108:109], v126 offset:8192
    ds_read_b64_tr_b16 v[110:111], v126 offset:8704
    s_waitcnt lgkmcnt(7)
    v_mfma_f32_32x32x16_bf16 v[32:47], v[88:91], v[80:83], v[32:47]
    ds_read_b128 v[64:67], v122 offset:0
    ds_read_b64_tr_b16 v[68:69], v126 offset:12288
    ds_read_b64_tr_b16 v[70:71], v126 offset:12800
    v_mfma_f32_32x32x16_bf16 v[48:63], v[80:83], v[92:95], v[48:63]
    ds_read_b64_tr_b16 v[72:73], v126 offset:13312
    ds_read_b64_tr_b16 v[74:75], v126 offset:13824
    v_mfma_f32_32x32x16_bf16 v[16:31], v[84:87], v[80:83], v[16:31]
    ds_read_b64_tr_b16 v[76:77], v126 offset:14336
    ds_read_b64_tr_b16 v[78:79], v126 offset:14848
    s_waitcnt lgkmcnt(7)
    v_mfma_f32_32x32x16_bf16 v[32:47], v[104:107], v[96:99], v[32:47]
    ds_read_b128 v[80:83], v123 offset:0
    ds_read_b64_tr_b16 v[84:85], v126 offset:18432
    ds_read_b64_tr_b16 v[86:87], v126 offset:18944
    v_mfma_f32_32x32x16_bf16 v[48:63], v[96:99], v[108:111], v[48:63]
    ds_read_b64_tr_b16 v[88:89], v126 offset:19456
    ds_read_b64_tr_b16 v[90:91], v126 offset:19968
    v_mfma_f32_32x32x16_bf16 v[16:31], v[100:103], v[96:99], v[16:31]
    ds_read_b64_tr_b16 v[92:93], v126 offset:20480
    ds_read_b64_tr_b16 v[94:95], v126 offset:20992
    s_waitcnt lgkmcnt(7)
    v_mfma_f32_32x32x16_bf16 v[32:47], v[72:75], v[64:67], v[32:47]
    s_barrier
    ds_read_b128 v[96:99], v112 offset:0
    ds_read_b64_tr_b16 v[100:101], v124 offset:0
    ds_read_b64_tr_b16 v[102:103], v124 offset:512
    v_mfma_f32_32x32x16_bf16 v[48:63], v[64:67], v[76:79], v[48:63]
    ds_read_b64_tr_b16 v[104:105], v124 offset:1024
    ds_read_b64_tr_b16 v[106:107], v124 offset:1536
    v_mfma_f32_32x32x16_bf16 v[16:31], v[68:71], v[64:67], v[16:31]
    ds_read_b64_tr_b16 v[108:109], v124 offset:2048
    ds_read_b64_tr_b16 v[110:111], v124 offset:2560
    s_waitcnt lgkmcnt(7)
    v_mfma_f32_32x32x16_bf16 v[32:47], v[88:91], v[80:83], v[32:47]
    ds_read_b128 v[64:67], v113 offset:0
    ds_read_b64_tr_b16 v[68:69], v124 offset:6144
    ds_read_b64_tr_b16 v[70:71], v124 offset:6656
    v_mfma_f32_32x32x16_bf16 v[48:63], v[80:83], v[92:95], v[48:63]
    ds_read_b64_tr_b16 v[72:73], v124 offset:7168
    ds_read_b64_tr_b16 v[74:75], v124 offset:7680
    v_mfma_f32_32x32x16_bf16 v[16:31], v[84:87], v[80:83], v[16:31]
    ds_read_b64_tr_b16 v[76:77], v124 offset:8192
    ds_read_b64_tr_b16 v[78:79], v124 offset:8704
    s_waitcnt lgkmcnt(7)
    v_mfma_f32_32x32x16_bf16 v[32:47], v[104:107], v[96:99], v[32:47]
    ds_read_b128 v[80:83], v114 offset:0
    ds_read_b64_tr_b16 v[84:85], v124 offset:12288
    ds_read_b64_tr_b16 v[86:87], v124 offset:12800
    v_mfma_f32_32x32x16_bf16 v[48:63], v[96:99], v[108:111], v[48:63]
    ds_read_b64_tr_b16 v[88:89], v124 offset:13312
    ds_read_b64_tr_b16 v[90:91], v124 offset:13824
    v_mfma_f32_32x32x16_bf16 v[16:31], v[100:103], v[96:99], v[16:31]
    ds_read_b64_tr_b16 v[92:93], v124 offset:14336
    ds_read_b64_tr_b16 v[94:95], v124 offset:14848
    s_waitcnt lgkmcnt(7)
    v_mfma_f32_32x32x16_bf16 v[32:47], v[72:75], v[64:67], v[32:47]
    ds_read_b128 v[96:99], v115 offset:0
    ds_read_b64_tr_b16 v[100:101], v124 offset:18432
    ds_read_b64_tr_b16 v[102:103], v124 offset:18944
    v_mfma_f32_32x32x16_bf16 v[48:63], v[64:67], v[76:79], v[48:63]
    ds_read_b64_tr_b16 v[104:105], v124 offset:19456
    ds_read_b64_tr_b16 v[106:107], v124 offset:19968
    v_mfma_f32_32x32x16_bf16 v[16:31], v[68:71], v[64:67], v[16:31]
    ds_read_b64_tr_b16 v[108:109], v124 offset:20480
    ds_read_b64_tr_b16 v[110:111], v124 offset:20992
    s_waitcnt lgkmcnt(7)
    v_mfma_f32_32x32x16_bf16 v[32:47], v[88:91], v[80:83], v[32:47]
    s_barrier
    ds_read_b128 v[64:67], v112 offset:32768
    ds_read_b64_tr_b16 v[68:69], v124 offset:32768
    ds_read_b64_tr_b16 v[70:71], v124 offset:33280
    v_mfma_f32_32x32x16_bf16 v[48:63], v[80:83], v[92:95], v[48:63]
    ds_read_b64_tr_b16 v[72:73], v124 offset:33792
    ds_read_b64_tr_b16 v[74:75], v124 offset:34304
    v_mfma_f32_32x32x16_bf16 v[16:31], v[84:87], v[80:83], v[16:31]
    ds_read_b64_tr_b16 v[76:77], v124 offset:34816
    ds_read_b64_tr_b16 v[78:79], v124 offset:35328
    s_waitcnt lgkmcnt(7)
    v_mfma_f32_32x32x16_bf16 v[32:47], v[104:107], v[96:99], v[32:47]
    ds_read_b128 v[80:83], v113 offset:32768
    ds_read_b64_tr_b16 v[84:85], v124 offset:38912
    ds_read_b64_tr_b16 v[86:87], v124 offset:39424
    v_mfma_f32_32x32x16_bf16 v[48:63], v[96:99], v[108:111], v[48:63]
    ds_read_b64_tr_b16 v[88:89], v124 offset:39936
    ds_read_b64_tr_b16 v[90:91], v124 offset:40448
    v_mfma_f32_32x32x16_bf16 v[16:31], v[100:103], v[96:99], v[16:31]
    ds_read_b64_tr_b16 v[92:93], v124 offset:40960
    ds_read_b64_tr_b16 v[94:95], v124 offset:41472
    s_waitcnt lgkmcnt(7)
    v_mfma_f32_32x32x16_bf16 v[32:47], v[72:75], v[64:67], v[32:47]
    ds_read_b128 v[96:99], v114 offset:32768
    ds_read_b64_tr_b16 v[100:101], v124 offset:45056
    ds_read_b64_tr_b16 v[102:103], v124 offset:45568
    v_mfma_f32_32x32x16_bf16 v[48:63], v[64:67], v[76:79], v[48:63]
    ds_read_b64_tr_b16 v[104:105], v124 offset:46080
    ds_read_b64_tr_b16 v[106:107], v124 offset:46592
    v_mfma_f32_32x32x16_bf16 v[16:31], v[68:71], v[64:67], v[16:31]
    ds_read_b64_tr_b16 v[108:109], v124 offset:47104
    ds_read_b64_tr_b16 v[110:111], v124 offset:47616
    s_waitcnt lgkmcnt(7)
    v_mfma_f32_32x32x16_bf16 v[32:47], v[88:91], v[80:83], v[32:47]
    ds_read_b128 v[64:67], v115 offset:32768
    ds_read_b64_tr_b16 v[68:69], v124 offset:51200
    ds_read_b64_tr_b16 v[70:71], v124 offset:51712
    v_mfma_f32_32x32x16_bf16 v[48:63], v[80:83], v[92:95], v[48:63]
    ds_read_b64_tr_b16 v[72:73], v124 offset:52224
    ds_read_b64_tr_b16 v[74:75], v124 offset:52736
    v_mfma_f32_32x32x16_bf16 v[16:31], v[84:87], v[80:83], v[16:31]
    ds_read_b64_tr_b16 v[76:77], v124 offset:53248
    ds_read_b64_tr_b16 v[78:79], v124 offset:53760
    s_waitcnt lgkmcnt(7)
    v_mfma_f32_32x32x16_bf16 v[32:47], v[104:107], v[96:99], v[32:47]
    s_barrier
    ds_read_b128 v[80:83], v116 offset:0
    ds_read_b64_tr_b16 v[84:85], v125 offset:0
    ds_read_b64_tr_b16 v[86:87], v125 offset:512
    v_mfma_f32_32x32x16_bf16 v[48:63], v[96:99], v[108:111], v[48:63]
    ds_read_b64_tr_b16 v[88:89], v125 offset:1024
    ds_read_b64_tr_b16 v[90:91], v125 offset:1536
    v_mfma_f32_32x32x16_bf16 v[16:31], v[100:103], v[96:99], v[16:31]
    ds_read_b64_tr_b16 v[92:93], v125 offset:2048
    ds_read_b64_tr_b16 v[94:95], v125 offset:2560
    s_waitcnt lgkmcnt(7)
    v_mfma_f32_32x32x16_bf16 v[32:47], v[72:75], v[64:67], v[32:47]
    ds_read_b128 v[96:99], v117 offset:0
    ds_read_b64_tr_b16 v[100:101], v125 offset:6144
    ds_read_b64_tr_b16 v[102:103], v125 offset:6656
    v_mfma_f32_32x32x16_bf16 v[48:63], v[64:67], v[76:79], v[48:63]
    ds_read_b64_tr_b16 v[104:105], v125 offset:7168
    ds_read_b64_tr_b16 v[106:107], v125 offset:7680
    v_mfma_f32_32x32x16_bf16 v[16:31], v[68:71], v[64:67], v[16:31]
    ds_read_b64_tr_b16 v[108:109], v125 offset:8192
    ds_read_b64_tr_b16 v[110:111], v125 offset:8704
    s_waitcnt lgkmcnt(7)
    v_mfma_f32_32x32x16_bf16 v[32:47], v[88:91], v[80:83], v[32:47]
    ds_read_b128 v[64:67], v118 offset:0
    ds_read_b64_tr_b16 v[68:69], v125 offset:12288
    ds_read_b64_tr_b16 v[70:71], v125 offset:12800
    v_mfma_f32_32x32x16_bf16 v[48:63], v[80:83], v[92:95], v[48:63]
    ds_read_b64_tr_b16 v[72:73], v125 offset:13312
    ds_read_b64_tr_b16 v[74:75], v125 offset:13824
    v_mfma_f32_32x32x16_bf16 v[16:31], v[84:87], v[80:83], v[16:31]
    ds_read_b64_tr_b16 v[76:77], v125 offset:14336
    ds_read_b64_tr_b16 v[78:79], v125 offset:14848
    s_waitcnt lgkmcnt(7)
    v_mfma_f32_32x32x16_bf16 v[32:47], v[104:107], v[96:99], v[32:47]
    ds_read_b128 v[80:83], v119 offset:0
    ds_read_b64_tr_b16 v[84:85], v125 offset:18432
    ds_read_b64_tr_b16 v[86:87], v125 offset:18944
    v_mfma_f32_32x32x16_bf16 v[48:63], v[96:99], v[108:111], v[48:63]
    ds_read_b64_tr_b16 v[88:89], v125 offset:19456
    ds_read_b64_tr_b16 v[90:91], v125 offset:19968
    v_mfma_f32_32x32x16_bf16 v[16:31], v[100:103], v[96:99], v[16:31]
    ds_read_b64_tr_b16 v[92:93], v125 offset:20480
    ds_read_b64_tr_b16 v[94:95], v125 offset:20992
    s_waitcnt lgkmcnt(7)
    v_mfma_f32_32x32x16_bf16 v[32:47], v[72:75], v[64:67], v[32:47]
    s_barrier
    v_mfma_f32_32x32x16_bf16 v[48:63], v[64:67], v[76:79], v[48:63]
    v_mfma_f32_32x32x16_bf16 v[16:31], v[68:71], v[64:67], v[16:31]
    s_waitcnt lgkmcnt(0)
    v_mfma_f32_32x32x16_bf16 v[32:47], v[88:91], v[80:83], v[32:47]
    v_mfma_f32_32x32x16_bf16 v[48:63], v[80:83], v[92:95], v[48:63]
    v_mfma_f32_32x32x16_bf16 v[16:31], v[84:87], v[80:83], v[16:31]
    s_waitcnt vmcnt(0)
    s_mov_b32 s50, 30000
L_gt_17:
    v_readfirstlane_b32 s44, v9
    s_nop 1
    s_cmp_lg_u32 s44, 0
    s_cbranch_scc1 L_gtd_18
    s_sleep 4
    buffer_load_dword v9, v10, s[36:39], 0 offen sc1
    s_sub_u32 s50, s50, 1
    s_cmp_lg_u32 s50, 0
    s_waitcnt vmcnt(0)
    s_cbranch_scc1 L_gt_17
L_gtd_18:
    s_nop 2
    v_cvt_pk_bf16_f32 v64, v32, v33
    v_cvt_pk_bf16_f32 v65, v34, v35
    v_cvt_pk_bf16_f32 v66, v36, v37
    v_cvt_pk_bf16_f32 v67, v38, v39
    v_cvt_pk_bf16_f32 v68, v40, v41
    v_cvt_pk_bf16_f32 v69, v42, v43
    v_cvt_pk_bf16_f32 v70, v44, v45
    v_cvt_pk_bf16_f32 v71, v46, v47
    buffer_store_dwordx4 v[64:67], v2, s[40:43], s58 offen sc1
    buffer_store_dwordx4 v[68:71], v2, s[40:43], s59 offen sc1
    v_cvt_pk_bf16_f32 v72, v48, v49
    v_cvt_pk_bf16_f32 v73, v50, v51
    v_cvt_pk_bf16_f32 v74, v52, v53
    v_cvt_pk_bf16_f32 v75, v54, v55
    v_cvt_pk_bf16_f32 v76, v56, v57
    v_cvt_pk_bf16_f32 v77, v58, v59
    v_cvt_pk_bf16_f32 v78, v60, v61
    v_cvt_pk_bf16_f32 v79, v62, v63
    buffer_store_dwordx4 v[72:75], v3, s[40:43], s58 offen offset:1024 sc1
    buffer_store_dwordx4 v[76:79], v3, s[40:43], s58 offen offset:1536 sc1
    v_mul_f32 v16, s60, v16
    v_mul_f32 v17, s60, v17
    v_mul_f32 v18, s60, v18
    v_mul_f32 v19, s60, v19
    v_mul_f32 v20, s60, v20
    v_mul_f32 v21, s60, v21
    v_mul_f32 v22, s60, v22
    v_mul_f32 v23, s60, v23
    v_mul_f32 v24, s60, v24
    v_mul_f32 v25, s60, v25
    v_mul_f32 v26, s60, v26
    v_mul_f32 v27, s60, v27
    v_mul_f32 v28, s60, v28
    v_mul_f32 v29, s60, v29
    v_mul_f32 v30, s60, v30
    v_mul_f32 v31, s60, v31
    v_cvt_pk_bf16_f32 v80, v16, v17
    v_cvt_pk_bf16_f32 v81, v18, v19
    v_cvt_pk_bf16_f32 v82, v20, v21
    v_cvt_pk_bf16_f32 v83, v22, v23
    v_cvt_pk_bf16_f32 v84, v24, v25
    v_cvt_pk_bf16_f32 v85, v26, v27
    v_cvt_pk_bf16_f32 v86, v28, v29
    v_cvt_pk_bf16_f32 v87, v30, v31
    buffer_store_dwordx4 v[80:83], v2, s[40:43], s56 offen sc1
    buffer_store_dwordx4 v[84:87], v2, s[40:43], s57 offen sc1
    s_barrier
    s_lshl_b32 s58, s4, 2
    s_and_b32 s50, s5, 3
    s_add_u32 s58, s58, s50
    s_lshr_b32 s59, s5, 2
    s_lshl_b32 s59, s59, 3
    s_and_b32 s50, s3, 3
    s_lshl_b32 s50, s50, 1
    s_add_u32 s59, s59, s50
    s_lshr_b32 s60, s3, 2
    v_lshlrev_b32 v6, 4, v1
    s_lshl_b32 s61, s7, 12
    s_lshl_b32 s57, s6, 7
    s_add_u32 s61, s61, s57
    s_lshl_b32 s57, s3, 2
    s_add_u32 s61, s61, s57
    s_add_u32 s61, s61, 12582912
    s_lshl_b32 s62, s4, 12
    s_add_u32 s62, s62, 12582912
    s_mov_b32 s63, 0
    v_lshrrev_b32 v10, 1, v1
    v_lshlrev_b32 v10, 7, v10
    v_and_b32 v11, 1, v1
    v_lshlrev_b32 v11, 3, v11
    v_add_u32 v10, v10, v11
    v_lshrrev_b32 v7, 5, v1
    v_lshlrev_b32 v7, 8, v7
    v_and_b32 v9, 15, v1
    v_lshlrev_b32 v9, 4, v9
    v_add_u32 v7, v7, v9
    v_add_u32 v7, 33792, v7
    v_and_b32 v8, 3, v1
    v_lshlrev_b32 v8, 2, v8
    v_add_u32 v8, 30720, v8
    s_lshl_b32 s50, s60, 13
    v_add_u32 v15, 32768, v6
    v_add_u32 v13, s50, v15
    v_add_u32 v14, s50, v7
    v_add_u32 v92, 16384, v13
    v_add_u32 v93, 16384, v14
    v_mov_b32 v104, 0
    v_mov_b32 v105, 0
    v_mov_b32 v106, 0
    v_mov_b32 v107, 0
    v_mov_b32 v108, 0
    v_mov_b32 v109, 0
    v_mov_b32 v110, 0
    v_mov_b32 v111, 0
    v_mov_b32 v112, 0
    v_mov_b32 v113, 0
    v_mov_b32 v114, 0
    v_mov_b32 v115, 0
    v_mov_b32 v116, 0
    v_mov_b32 v117, 0
    v_mov_b32 v118, 0
    v_mov_b32 v119, 0
    s_mov_b32 exec_lo, 0x110000
    s_mov_b32 exec_hi, 0x110000
    v_mov_b32 v104, 0x3f803f80
    v_mov_b32 v105, 0x3f803f80
    v_mov_b32 v106, 0x3f803f80
    v_mov_b32 v107, 0x3f803f80
    v_mov_b32 v108, 0x3f803f80
    v_mov_b32 v109, 0x3f803f80
    v_mov_b32 v110, 0x3f803f80
    v_mov_b32 v111, 0x3f803f80
    v_mov_b32 v112, 0x3f803f80
    v_mov_b32 v113, 0x3f803f80
    v_mov_b32 v114, 0x3f803f80
    v_mov_b32 v115, 0x3f803f80
    v_mov_b32 v116, 0x3f803f80
    v_mov_b32 v117, 0x3f803f80
    v_mov_b32 v118, 0x3f803f80
    v_mov_b32 v119, 0x3f803f80
    s_mov_b64 exec, -1
    v_mov_b32 v32, 0
    v_mov_b32 v33, 0
    v_mov_b32 v34, 0
    v_mov_b32 v35, 0
    v_mov_b32 v36, 0
    v_mov_b32 v37, 0
    v_mov_b32 v38, 0
    v_mov_b32 v39, 0
    v_mov_b32 v40, 0
    v_mov_b32 v41, 0
    v_mov_b32 v42, 0
    v_mov_b32 v43, 0
    v_mov_b32 v44, 0
    v_mov_b32 v45, 0
    v_mov_b32 v46, 0
    v_mov_b32 v47, 0
    v_mov_b32 v140, 0
    v_mov_b32 v141, 0
    v_mov_b32 v142, 0
    v_mov_b32 v143, 0
    v_mov_b32 v144, 0
    v_mov_b32 v145, 0
    v_mov_b32 v146, 0
    v_mov_b32 v147, 0
    v_mov_b32 v148, 0
    v_mov_b32 v149, 0
    v_mov_b32 v150, 0
    v_mov_b32 v151, 0
    v_mov_b32 v152, 0
    v_mov_b32 v153, 0
    v_mov_b32 v154, 0
    v_mov_b32 v155, 0
    s_barrier
    s_mov_b32 s54, 4
L_tt_19:
    s_cmp_eq_u32 s63, 2
    s_cbranch_scc1 L_tk_20
    s_getreg_b32 s50, hwreg(HW_REG_IB_STS, 0, 4)
    s_cmp_lg_u32 s50, 0
    s_cbranch_scc1 L_tkw_23
    s_cmp_eq_u32 s63, 1
    s_cbranch_scc1 L_tk1_21
    v_mov_b32 v11, s44
    v_mov_b32 v12, 0
    s_mov_b64 exec, 1
    buffer_store_dword v11, v12, s[40:43], s61 offen sc1
    s_mov_b64 exec, -1
    s_cmp_eq_u32 s3, 0
    s_cselect_b32 s63, 1, 2
    s_cbranch_scc1 L_tkp_22
    s_branch L_tk_20
L_tk1_21:
L_tkp_22:
    v_mov_b32 v90, 0
    s_branch L_tk_20
L_tkw_23:
    s_sleep 1
    s_sub_u32 s54, s54, 1
    s_cmp_lg_u32 s54, 0
    s_cbranch_scc1 L_tt_19
L_tk_20:
    s_barrier
    s_mov_b32 s54, 4
L_tt_24:
    s_cmp_eq_u32 s63, 2
    s_cbranch_scc1 L_tk_25
    s_getreg_b32 s50, hwreg(HW_REG_IB_STS, 0, 4)
    s_cmp_lg_u32 s50, 0
    s_cbranch_scc1 L_tkw_28
    s_cmp_eq_u32 s63, 1
    s_cbranch_scc1 L_tk1_26
    v_mov_b32 v11, s44
    v_mov_b32 v12, 0
    s_mov_b64 exec, 1
    buffer_store_dword v11, v12, s[40:43], s61 offen sc1
    s_mov_b64 exec, -1
    s_cmp_eq_u32 s3, 0
    s_cselect_b32 s63, 1, 2
    s_cbranch_scc1 L_tkp_27
    s_branch L_tk_25
L_tk1_26:
L_tkp_27:
    v_mov_b32 v90, 0
    s_branch L_tk_25
L_tkw_28:
    s_sleep 1
    s_sub_u32 s54, s54, 1
    s_cmp_lg_u32 s54, 0
    s_cbranch_scc1 L_tt_24
L_tk_25:
    s_barrier
    s_mov_b32 s54, 4
L_tt_29:
    s_cmp_eq_u32 s63, 2
    s_cbranch_scc1 L_tk_30
    s_getreg_b32 s50, hwreg(HW_REG_IB_STS, 0, 4)
    s_cmp_lg_u32 s50, 0
    s_cbranch_scc1 L_tkw_33
    s_cmp_eq_u32 s63, 1
    s_cbranch_scc1 L_tk1_31
    v_mov_b32 v11, s44
    v_mov_b32 v12, 0
    s_mov_b64 exec, 1
    buffer_store_dword v11, v12, s[40:43], s61 offen sc1
    s_mov_b64 exec, -1
    s_cmp_eq_u32 s3, 0
    s_cselect_b32 s63, 1, 2
    s_cbranch_scc1 L_tkp_32
    s_branch L_tk_30
L_tk1_31:
L_tkp_32:
    buffer_load_dwordx2 v[90:91], v10, s[40:43], s62 offen sc1
L_tkw_33:
    s_sleep 1
    s_sub_u32 s54, s54, 1
    s_cmp_lg_u32 s54, 0
    s_cbranch_scc1 L_tt_29
L_tk_30:
    s_barrier
    s_mov_b32 s54, 4
L_tt_34:
    s_cmp_eq_u32 s63, 2
    s_cbranch_scc1 L_tk_35
    s_getreg_b32 s50, hwreg(HW_REG_IB_STS, 0, 4)
    s_cmp_lg_u32 s50, 0
    s_cbranch_scc1 L_tkw_38
    s_cmp_eq_u32 s63, 1
    s_cbranch_scc1 L_tk1_36
    v_mov_b32 v11, s44
    v_mov_b32 v12, 0
    s_mov_b64 exec, 1
    buffer_store_dword v11, v12, s[40:43], s61 offen sc1
    s_mov_b64 exec, -1
    s_cmp_eq_u32 s3, 0
    s_cselect_b32 s63, 1, 2
    s_cbranch_scc1 L_tkp_37
    s_branch L_tk_35
L_tk1_36:
L_tkp_37:
    buffer_load_dwordx2 v[90:91], v10, s[40:43], s62 offen sc1
L_tkw_38:
    s_sleep 1
    s_sub_u32 s54, s54, 1
    s_cmp_lg_u32 s54, 0
    s_cbranch_scc1 L_tt_34
L_tk_35:
    s_barrier
    s_mov_b32 s54, 4
L_tt_39:
    s_cmp_eq_u32 s63, 2
    s_cbranch_scc1 L_tk_40
    s_getreg_b32 s50, hwreg(HW_REG_IB_STS, 0, 4)
    s_cmp_lg_u32 s50, 0
    s_cbranch_scc1 L_tkw_43
    s_cmp_eq_u32 s63, 1
    s_cbranch_scc1 L_tk1_41
    v_mov_b32 v11, s44
    v_mov_b32 v12, 0
    s_mov_b64 exec, 1
    buffer_store_dword v11, v12, s[40:43], s61 offen sc1
    s_mov_b64 exec, -1
    s_cmp_eq_u32 s3, 0
    s_cselect_b32 s63, 1, 2
    s_cbranch_scc1 L_tkp_42
    s_branch L_tk_40
L_tk1_41:
    v_cmp_ne_u32 vcc, s44, v90
    v_cmp_ne_u32 s[56:57], s44, v91
    s_nop 1
    s_or_b64 vcc, vcc, s[56:57]
    s_cmp_eq_u64 vcc, 0
    s_cbranch_scc0 L_tkp_42
    s_mov_b32 s56, 65536
    v_mov_b32 v11, s44
    v_mov_b32 v12, s56
    s_mov_b64 exec, 1
    ds_write_b32 v12, v11 offset:0
    s_mov_b64 exec, -1
    s_lshl_b32 s56, s58, 16
    s_lshl_b32 s57, s59, 10
    s_add_u32 s56, s56, s57
    buffer_load_dwordx4 v[2:5], v6, s[40:43], s56 offen sc1
    buffer_load_dwordx4 v[120:123], v6, s[40:43], s56 offen offset:1024 sc1
    s_mov_b32 s55, 0
    s_lshl_b32 s56, s58, 17
    s_mul_i32 s57, s55, 32768
    s_add_u32 s57, s57, 0
    s_add_u32 s56, s56, s57
    s_add_u32 s56, s56, 2097152
    s_add_u32 m0, s57, 32768
    s_add_u32 s55, s56, 0
    buffer_load_dwordx4 v6, s[40:43], s55 offen offset:0 sc1 lds
    buffer_load_dwordx4 v6, s[40:43], s55 offen offset:1024 sc1 lds
    buffer_load_dwordx4 v6, s[40:43], s55 offen offset:2048 sc1 lds
    buffer_load_dwordx4 v6, s[40:43], s55 offen offset:3072 sc1 lds
    s_add_u32 m0, s57, 36864
    s_add_u32 s55, s56, 4096
    buffer_load_dwordx4 v6, s[40:43], s55 offen offset:0 sc1 lds
    buffer_load_dwordx4 v6, s[40:43], s55 offen offset:1024 sc1 lds
    buffer_load_dwordx4 v6, s[40:43], s55 offen offset:2048 sc1 lds
    buffer_load_dwordx4 v6, s[40:43], s55 offen offset:3072 sc1 lds
    s_add_u32 m0, s57, 40960
    s_add_u32 s55, s56, 8192
    buffer_load_dwordx4 v6, s[40:43], s55 offen offset:0 sc1 lds
    buffer_load_dwordx4 v6, s[40:43], s55 offen offset:1024 sc1 lds
    buffer_load_dwordx4 v6, s[40:43], s55 offen offset:2048 sc1 lds
    buffer_load_dwordx4 v6, s[40:43], s55 offen offset:3072 sc1 lds
    s_add_u32 m0, s57, 45056
    s_add_u32 s55, s56, 12288
    buffer_load_dwordx4 v6, s[40:43], s55 offen offset:0 sc1 lds
    buffer_load_dwordx4 v6, s[40:43], s55 offen offset:1024 sc1 lds
    buffer_load_dwordx4 v6, s[40:43], s55 offen offset:2048 sc1 lds
    buffer_load_dwordx4 v6, s[40:43], s55 offen offset:3072 sc1 lds
    s_add_u32 m0, s57, 49152
    s_add_u32 s55, s56, 16384
    buffer_load_dwordx4 v6, s[40:43], s55 offen offset:0 sc1 lds
    buffer_load_dwordx4 v6, s[40:43], s55 offen offset:1024 sc1 lds
    buffer_load_dwordx4 v6, s[40:43], s55 offen offset:2048 sc1 lds
    buffer_load_dwordx4 v6, s[40:43], s55 offen offset:3072 sc1 lds
    s_add_u32 m0, s57, 53248
    s_add_u32 s55, s56, 20480
    buffer_load_dwordx4 v6, s[40:43], s55 offen offset:0 sc1 lds
    buffer_load_dwordx4 v6, s[40:43], s55 offen offset:1024 sc1 lds
    buffer_load_dwordx4 v6, s[40:43], s55 offen offset:2048 sc1 lds
    buffer_load_dwordx4 v6, s[40:43], s55 offen offset:3072 sc1 lds
    s_add_u32 m0, s57, 57344
    s_add_u32 s55, s56, 24576
    buffer_load_dwordx4 v6, s[40:43], s55 offen offset:0 sc1 lds
    buffer_load_dwordx4 v6, s[40:43], s55 offen offset:1024 sc1 lds
    buffer_load_dwordx4 v6, s[40:43], s55 offen offset:2048 sc1 lds
    buffer_load_dwordx4 v6, s[40:43], s55 offen offset:3072 sc1 lds
    s_add_u32 m0, s57, 61440
    s_add_u32 s55, s56, 28672
    buffer_load_dwordx4 v6, s[40:43], s55 offen offset:0 sc1 lds
    buffer_load_dwordx4 v6, s[40:43], s55 offen offset:1024 sc1 lds
    buffer_load_dwordx4 v6, s[40:43], s55 offen offset:2048 sc1 lds
    buffer_load_dwordx4 v6, s[40:43], s55 offen offset:3072 sc1 lds
    s_mov_b32 s63, 2
    s_branch L_tk_40
L_tkp_42:
    buffer_load_dwordx2 v[90:91], v10, s[40:43], s62 offen sc1
L_tkw_43:
    s_sleep 1
    s_sub_u32 s54, s54, 1
    s_cmp_lg_u32 s54, 0
    s_cbranch_scc1 L_tt_39
L_tk_40:
    s_barrier
    s_mov_b32 s54, 4
L_tt_44:
    s_cmp_eq_u32 s63, 2
    s_cbranch_scc1 L_tk_45
    s_getreg_b32 s50, hwreg(HW_REG_IB_STS, 0, 4)
    s_cmp_lg_u32 s50, 0
    s_cbranch_scc1 L_tkw_48
    s_cmp_eq_u32 s63, 1
    s_cbranch_scc1 L_tk1_46
    v_mov_b32 v11, s44
    v_mov_b32 v12, 0
    s_mov_b64 exec, 1
    buffer_store_dword v11, v12, s[40:43], s61 offen sc1
    s_mov_b64 exec, -1
    s_cmp_eq_u32 s3, 0
    s_cselect_b32 s63, 1, 2
    s_cbranch_scc1 L_tkp_47
    s_branch L_tk_45
L_tk1_46:
    v_cmp_ne_u32 vcc, s44, v90
    v_cmp_ne_u32 s[56:57], s44, v91
    s_nop 1
    s_or_b64 vcc, vcc, s[56:57]
    s_cmp_eq_u64 vcc, 0
    s_cbranch_scc0 L_tkp_47
    s_mov_b32 s56, 65536
    v_mov_b32 v11, s44
    v_mov_b32 v12, s56
    s_mov_b64 exec, 1
    ds_write_b32 v12, v11 offset:0
    s_mov_b64 exec, -1
    s_lshl_b32 s56, s58, 16
    s_lshl_b32 s57, s59, 10
    s_add_u32 s56, s56, s57
    buffer_load_dwordx4 v[2:5], v6, s[40:43], s56 offen sc1
    buffer_load_dwordx4 v[120:123], v6, s[40:43], s56 offen offset:1024 sc1
    s_mov_b32 s55, 0
    s_lshl_b32 s56, s58, 17
    s_mul_i32 s57, s55, 32768
    s_add_u32 s57, s57, 0
    s_add_u32 s56, s56, s57
    s_add_u32 s56, s56, 2097152
    s_add_u32 m0, s57, 32768
    s_add_u32 s55, s56, 0
    buffer_load_dwordx4 v6, s[40:43], s55 offen offset:0 sc1 lds
    buffer_load_dwordx4 v6, s[40:43], s55 offen offset:1024 sc1 lds
    buffer_load_dwordx4 v6, s[40:43], s55 offen offset:2048 sc1 lds
    buffer_load_dwordx4 v6, s[40:43], s55 offen offset:3072 sc1 lds
    s_add_u32 m0, s57, 36864
    s_add_u32 s55, s56, 4096
    buffer_load_dwordx4 v6, s[40:43], s55 offen offset:0 sc1 lds
    buffer_load_dwordx4 v6, s[40:43], s55 offen offset:1024 sc1 lds
    buffer_load_dwordx4 v6, s[40:43], s55 offen offset:2048 sc1 lds
    buffer_load_dwordx4 v6, s[40:43], s55 offen offset:3072 sc1 lds
    s_add_u32 m0, s57, 40960
    s_add_u32 s55, s56, 8192
    buffer_load_dwordx4 v6, s[40:43], s55 offen offset:0 sc1 lds
    buffer_load_dwordx4 v6, s[40:43], s55 offen offset:1024 sc1 lds
    buffer_load_dwordx4 v6, s[40:43], s55 offen offset:2048 sc1 lds
    buffer_load_dwordx4 v6, s[40:43], s55 offen offset:3072 sc1 lds
    s_add_u32 m0, s57, 45056
    s_add_u32 s55, s56, 12288
    buffer_load_dwordx4 v6, s[40:43], s55 offen offset:0 sc1 lds
    buffer_load_dwordx4 v6, s[40:43], s55 offen offset:1024 sc1 lds
    buffer_load_dwordx4 v6, s[40:43], s55 offen offset:2048 sc1 lds
    buffer_load_dwordx4 v6, s[40:43], s55 offen offset:3072 sc1 lds
    s_add_u32 m0, s57, 49152
    s_add_u32 s55, s56, 16384
    buffer_load_dwordx4 v6, s[40:43], s55 offen offset:0 sc1 lds
    buffer_load_dwordx4 v6, s[40:43], s55 offen offset:1024 sc1 lds
    buffer_load_dwordx4 v6, s[40:43], s55 offen offset:2048 sc1 lds
    buffer_load_dwordx4 v6, s[40:43], s55 offen offset:3072 sc1 lds
    s_add_u32 m0, s57, 53248
    s_add_u32 s55, s56, 20480
    buffer_load_dwordx4 v6, s[40:43], s55 offen offset:0 sc1 lds
    buffer_load_dwordx4 v6, s[40:43], s55 offen offset:1024 sc1 lds
    buffer_load_dwordx4 v6, s[40:43], s55 offen offset:2048 sc1 lds
    buffer_load_dwordx4 v6, s[40:43], s55 offen offset:3072 sc1 lds
    s_add_u32 m0, s57, 57344
    s_add_u32 s55, s56, 24576
    buffer_load_dwordx4 v6, s[40:43], s55 offen offset:0 sc1 lds
    buffer_load_dwordx4 v6, s[40:43], s55 offen offset:1024 sc1 lds
    buffer_load_dwordx4 v6, s[40:43], s55 offen offset:2048 sc1 lds
    buffer_load_dwordx4 v6, s[40:43], s55 offen offset:3072 sc1 lds
    s_add_u32 m0, s57, 61440
    s_add_u32 s55, s56, 28672
    buffer_load_dwordx4 v6, s[40:43], s55 offen offset:0 sc1 lds
    buffer_load_dwordx4 v6, s[40:43], s55 offen offset:1024 sc1 lds
    buffer_load_dwordx4 v6, s[40:43], s55 offen offset:2048 sc1 lds
    buffer_load_dwordx4 v6, s[40:43], s55 offen offset:3072 sc1 lds
    s_mov_b32 s63, 2
    s_branch L_tk_45
L_tkp_47:
    buffer_load_dwordx2 v[90:91], v10, s[40:43], s62 offen sc1
L_tkw_48:
    s_sleep 1
    s_sub_u32 s54, s54, 1
    s_cmp_lg_u32 s54, 0
    s_cbranch_scc1 L_tt_44
L_tk_45:
    s_cmp_eq_u32 s3, 0
    s_cbranch_scc1 L_noqt_49
    s_cmp_lg_u32 s63, 2
    s_cbranch_scc1 L_noqt_49
    v_mov_b32 v10, 65536
    s_mov_b32 s54, 4
L_qt_50:
    ds_read_b32 v11, v10
    s_waitcnt lgkmcnt(0)
    v_cmp_ne_u32 vcc, s44, v11
    s_nop 1
    s_cmp_eq_u64 vcc, 0
    s_cbranch_scc1 L_qtg_52
    s_sub_u32 s54, s54, 1
    s_cmp_lg_u32 s54, 0
    s_cbranch_scc1 L_qt_50
    s_branch L_qtd_51
L_qtg_52:
    s_lshl_b32 s56, s58, 16
    s_lshl_b32 s57, s59, 10
    s_add_u32 s56, s56, s57
    buffer_load_dwordx4 v[2:5], v6, s[40:43], s56 offen sc1
    buffer_load_dwordx4 v[120:123], v6, s[40:43], s56 offen offset:1024 sc1
    s_mov_b32 s63, 3
L_qtd_51:
L_noqt_49:
    s_barrier
    s_cmp_lg_u32 s63, 0
    s_cbranch_scc1 L_fin0_53
    s_waitcnt vmcnt(0)
    v_mov_b32 v11, s44
    v_mov_b32 v12, 0
    s_mov_b64 exec, 1
    buffer_store_dword v11, v12, s[40:43], s61 offen sc1
    s_mov_b64 exec, -1
    s_cmp_lg_u32 s3, 0
    s_cbranch_scc1 L_qwait_5
    s_mov_b32 s63, 1
    buffer_load_dwordx2 v[90:91], v10, s[40:43], s62 offen sc1
L_fin0_53:
    s_cmp_lg_u32 s3, 0
    s_cbranch_scc1 L_qwait_5
    s_cmp_eq_u32 s63, 2
    s_cbranch_scc1 L_fin1_54
    s_mov_b32 s54, 30000
L_finp_55:
    s_waitcnt vmcnt(0)
    v_cmp_ne_u32 vcc, s44, v90
    v_cmp_ne_u32 s[56:57], s44, v91
    s_nop 1
    s_or_b64 vcc, vcc, s[56:57]
    s_cmp_eq_u64 vcc, 0
    s_cbranch_scc0 L_finf_56
    s_lshl_b32 s56, s58, 16
    s_lshl_b32 s57, s59, 10
    s_add_u32 s56, s56, s57
    buffer_load_dwordx4 v[2:5], v6, s[40:43], s56 offen sc1
    buffer_load_dwordx4 v[120:123], v6, s[40:43], s56 offen offset:1024 sc1
    s_mov_b32 s55, 0
    s_lshl_b32 s56, s58, 17
    s_mul_i32 s57, s55, 32768
    s_add_u32 s57, s57, 0
    s_add_u32 s56, s56, s57
    s_add_u32 s56, s56, 2097152
    s_add_u32 m0, s57, 32768
    s_add_u32 s55, s56, 0
    buffer_load_dwordx4 v6, s[40:43], s55 offen offset:0 sc1 lds
    buffer_load_dwordx4 v6, s[40:43], s55 offen offset:1024 sc1 lds
    buffer_load_dwordx4 v6, s[40:43], s55 offen offset:2048 sc1 lds
    buffer_load_dwordx4 v6, s[40:43], s55 offen offset:3072 sc1 lds
    s_add_u32 m0, s57, 36864
    s_add_u32 s55, s56, 4096
    buffer_load_dwordx4 v6, s[40:43], s55 offen offset:0 sc1 lds
    buffer_load_dwordx4 v6, s[40:43], s55 offen offset:1024 sc1 lds
    buffer_load_dwordx4 v6, s[40:43], s55 offen offset:2048 sc1 lds
    buffer_load_dwordx4 v6, s[40:43], s55 offen offset:3072 sc1 lds
    s_add_u32 m0, s57, 40960
    s_add_u32 s55, s56, 8192
    buffer_load_dwordx4 v6, s[40:43], s55 offen offset:0 sc1 lds
    buffer_load_dwordx4 v6, s[40:43], s55 offen offset:1024 sc1 lds
    buffer_load_dwordx4 v6, s[40:43], s55 offen offset:2048 sc1 lds
    buffer_load_dwordx4 v6, s[40:43], s55 offen offset:3072 sc1 lds
    s_add_u32 m0, s57, 45056
    s_add_u32 s55, s56, 12288
    buffer_load_dwordx4 v6, s[40:43], s55 offen offset:0 sc1 lds
    buffer_load_dwordx4 v6, s[40:43], s55 offen offset:1024 sc1 lds
    buffer_load_dwordx4 v6, s[40:43], s55 offen offset:2048 sc1 lds
    buffer_load_dwordx4 v6, s[40:43], s55 offen offset:3072 sc1 lds
    s_add_u32 m0, s57, 49152
    s_add_u32 s55, s56, 16384
    buffer_load_dwordx4 v6, s[40:43], s55 offen offset:0 sc1 lds
    buffer_load_dwordx4 v6, s[40:43], s55 offen offset:1024 sc1 lds
    buffer_load_dwordx4 v6, s[40:43], s55 offen offset:2048 sc1 lds
    buffer_load_dwordx4 v6, s[40:43], s55 offen offset:3072 sc1 lds
    s_add_u32 m0, s57, 53248
    s_add_u32 s55, s56, 20480
    buffer_load_dwordx4 v6, s[40:43], s55 offen offset:0 sc1 lds
    buffer_load_dwordx4 v6, s[40:43], s55 offen offset:1024 sc1 lds
    buffer_load_dwordx4 v6, s[40:43], s55 offen offset:2048 sc1 lds
    buffer_load_dwordx4 v6, s[40:43], s55 offen offset:3072 sc1 lds
    s_add_u32 m0, s57, 57344
    s_add_u32 s55, s56, 24576
    buffer_load_dwordx4 v6, s[40:43], s55 offen offset:0 sc1 lds
    buffer_load_dwordx4 v6, s[40:43], s55 offen offset:1024 sc1 lds
    buffer_load_dwordx4 v6, s[40:43], s55 offen offset:2048 sc1 lds
    buffer_load_dwordx4 v6, s[40:43], s55 offen offset:3072 sc1 lds
    s_add_u32 m0, s57, 61440
    s_add_u32 s55, s56, 28672
    buffer_load_dwordx4 v6, s[40:43], s55 offen offset:0 sc1 lds
    buffer_load_dwordx4 v6, s[40:43], s55 offen offset:1024 sc1 lds
    buffer_load_dwordx4 v6, s[40:43], s55 offen offset:2048 sc1 lds
    buffer_load_dwordx4 v6, s[40:43], s55 offen offset:3072 sc1 lds
    s_mov_b32 s63, 2
    s_branch L_fin1_54
L_finf_56:
    buffer_load_dwordx2 v[90:91], v10, s[40:43], s62 offen sc1
    s_sub_u32 s54, s54, 1
    s_cmp_lg_u32 s54, 0
    s_cbranch_scc1 L_finp_55
L_fin1_54:
    s_mov_b32 s56, 30720
    v_mov_b32 v10, s44
    v_mov_b32 v11, s56
    s_mov_b64 exec, 1
    ds_write_b32 v11, v10 offset:120
    s_mov_b64 exec, -1
    s_waitcnt vmcnt(0)
    v_mov_b32 v10, s44
    v_mov_b32 v11, s56
    s_mov_b64 exec, 1
    ds_write_b32 v11, v10 offset:48
    s_mov_b64 exec, -1
L_att_3:
    v_mov_b32 v84, 0
    v_mov_b32 v85, 0
    v_mov_b32 v86, 0
    v_mov_b32 v87, 0
    ds_read_b128 v[88:91], v15
    ds_read_b128 v[96:99], v13
    ds_read_b128 v[100:103], v13 offset:2048
    s_mov_b64 exec, s[46:47]
    ds_read_b128 v[104:107], v14
    ds_read_b128 v[108:111], v14 offset:512
    s_mov_b64 exec, -1
    s_waitcnt vmcnt(0) lgkmcnt(4)
    v_mfma_f32_32x32x16_bf16 v[48:63], v[88:91], v[2:5], 0
    v_mfma_f32_32x32x16_bf16 v[64:79], v[88:91], v[120:123], 0
    s_nop 10
    v_max3_f32 v11, v48, v49, v50
    v_max3_f32 v11, v11, v51, v52
    v_max3_f32 v11, v11, v53, v54
    v_max3_f32 v11, v11, v55, v56
    v_max3_f32 v11, v11, v57, v58
    v_max3_f32 v11, v11, v59, v60
    v_max3_f32 v11, v11, v61, v62
    v_max_f32 v11, v11, v63
    v_mov_b32 v12, v11
    s_nop 1
    v_permlane32_swap_b32 v11, v12
    s_nop 1
    v_max_f32 v11, v11, v12
    v_sub_f32 v16, 0, v11
    v_sub_f32 v17, 0, v11
    v_pk_mov_b32 v[18:19], v[16:17], v[16:17]
    v_pk_mov_b32 v[20:21], v[16:17], v[16:17]
    v_pk_mov_b32 v[22:23], v[16:17], v[16:17]
    v_pk_mov_b32 v[24:25], v[16:17], v[16:17]
    v_pk_mov_b32 v[26:27], v[16:17], v[16:17]
    v_pk_mov_b32 v[28:29], v[16:17], v[16:17]
    v_pk_mov_b32 v[30:31], v[16:17], v[16:17]
    v_max3_f32 v11, v64, v65, v66
    v_max3_f32 v11, v11, v67, v68
    v_max3_f32 v11, v11, v69, v70
    v_max3_f32 v11, v11, v71, v72
    v_max3_f32 v11, v11, v73, v74
    v_max3_f32 v11, v11, v75, v76
    v_max3_f32 v11, v11, v77, v78
    v_max_f32 v11, v11, v79
    v_mov_b32 v12, v11
    s_nop 1
    v_permlane32_swap_b32 v11, v12
    s_nop 1
    v_max_f32 v11, v11, v12
    v_sub_f32 v124, 0, v11
    v_sub_f32 v125, 0, v11
    v_pk_mov_b32 v[126:127], v[124:125], v[124:125]
    v_pk_mov_b32 v[128:129], v[124:125], v[124:125]
    v_pk_mov_b32 v[130:131], v[124:125], v[124:125]
    v_pk_mov_b32 v[132:133], v[124:125], v[124:125]
    v_pk_mov_b32 v[134:135], v[124:125], v[124:125]
    v_pk_mov_b32 v[136:137], v[124:125], v[124:125]
    v_pk_mov_b32 v[138:139], v[124:125], v[124:125]
    s_setprio 2
    s_mov_b32 s62, 0
    s_waitcnt lgkmcnt(3)
    v_mfma_f32_32x32x16_bf16 v[48:63], v[96:99], v[2:5], v[16:31]
    s_nop 5
.p2align 6
L_att_loop_57:
    s_cmp_eq_u32 s62, 1
    s_cbranch_scc1 L_att_s1_58
    s_cmp_eq_u32 s62, 4
    s_cbranch_scc1 L_att_s2_59
    s_cmp_eq_u32 s62, 7
    s_cbranch_scc1 L_att_s3_60
L_att_body_61:
    v_mfma_f32_32x32x16_bf16 v[64:79], v[96:99], v[120:123], v[124:139]
    v_exp_f32 v48, v48
    v_exp_f32 v49, v49
    v_exp_f32 v50, v50
    v_exp_f32 v51, v51
    v_mfma_f32_32x32x16_bf16 v[140:155], v[116:119], v[84:87], v[140:155]
    s_mov_b64 exec, s[46:47]
    ds_read_b128 v[112:115], v14 offset:2048
    ds_read_b128 v[116:119], v14 offset:2560
    s_mov_b64 exec, -1
    v_cvt_pk_bf16_f32 v80, v48, v49
    v_exp_f32 v52, v52
    v_exp_f32 v53, v53
    v_cvt_pk_bf16_f32 v81, v50, v51
    v_exp_f32 v54, v54
    v_exp_f32 v55, v55
    v_cvt_pk_bf16_f32 v82, v52, v53
    v_exp_f32 v56, v56
    v_cvt_pk_bf16_f32 v83, v54, v55
    v_exp_f32 v57, v57
    v_exp_f32 v58, v58
    s_waitcnt lgkmcnt(3)
    v_mfma_f32_32x32x16_bf16 v[32:47], v[104:107], v[80:83], v[32:47]
    v_exp_f32 v59, v59
    v_cvt_pk_bf16_f32 v84, v56, v57
    v_exp_f32 v60, v60
    v_exp_f32 v61, v61
    v_cvt_pk_bf16_f32 v85, v58, v59
    v_exp_f32 v62, v62
    v_exp_f32 v63, v63
    v_cvt_pk_bf16_f32 v86, v60, v61
    v_cvt_pk_bf16_f32 v87, v62, v63
    s_waitcnt lgkmcnt(2)
    v_mfma_f32_32x32x16_bf16 v[48:63], v[100:103], v[2:5], v[16:31]
    ds_read_b128 v[96:99], v13 offset:4096
    v_exp_f32 v64, v64
    v_exp_f32 v65, v65
    v_exp_f32 v66, v66
    v_exp_f32 v67, v67
    v_mfma_f32_32x32x16_bf16 v[32:47], v[108:111], v[84:87], v[32:47]
    v_cvt_pk_bf16_f32 v80, v64, v65
    v_exp_f32 v68, v68
    v_exp_f32 v69, v69
    v_cvt_pk_bf16_f32 v81, v66, v67
    v_exp_f32 v70, v70
    v_exp_f32 v71, v71
    v_cvt_pk_bf16_f32 v82, v68, v69
    v_exp_f32 v72, v72
    v_cvt_pk_bf16_f32 v83, v70, v71
    v_exp_f32 v73, v73
    v_exp_f32 v74, v74
    v_mfma_f32_32x32x16_bf16 v[140:155], v[104:107], v[80:83], v[140:155]
    v_exp_f32 v75, v75
    v_cvt_pk_bf16_f32 v84, v72, v73
    v_exp_f32 v76, v76
    v_exp_f32 v77, v77
    v_cvt_pk_bf16_f32 v85, v74, v75
    v_exp_f32 v78, v78
    v_exp_f32 v79, v79
    v_cvt_pk_bf16_f32 v86, v76, v77
    v_cvt_pk_bf16_f32 v87, v78, v79
    v_mfma_f32_32x32x16_bf16 v[64:79], v[100:103], v[120:123], v[124:139]
    v_exp_f32 v48, v48
    v_exp_f32 v49, v49
    v_exp_f32 v50, v50
    v_exp_f32 v51, v51
    v_mfma_f32_32x32x16_bf16 v[140:155], v[108:111], v[84:87], v[140:155]
    s_mov_b64 exec, s[46:47]
    ds_read_b128 v[104:107], v14 offset:4096
    ds_read_b128 v[108:111], v14 offset:4608
    s_mov_b64 exec, -1
    v_cvt_pk_bf16_f32 v80, v48, v49
    v_exp_f32 v52, v52
    v_exp_f32 v53, v53
    v_cvt_pk_bf16_f32 v81, v50, v51
    v_exp_f32 v54, v54
    v_exp_f32 v55, v55
    v_cvt_pk_bf16_f32 v82, v52, v53
    v_exp_f32 v56, v56
    v_cvt_pk_bf16_f32 v83, v54, v55
    v_exp_f32 v57, v57
    v_exp_f32 v58, v58
    s_waitcnt lgkmcnt(3)
    v_mfma_f32_32x32x16_bf16 v[32:47], v[112:115], v[80:83], v[32:47]
    v_exp_f32 v59, v59
    v_cvt_pk_bf16_f32 v84, v56, v57
    v_exp_f32 v60, v60
    v_exp_f32 v61, v61
    v_cvt_pk_bf16_f32 v85, v58, v59
    v_exp_f32 v62, v62
    v_exp_f32 v63, v63
    v_cvt_pk_bf16_f32 v86, v60, v61
    v_cvt_pk_bf16_f32 v87, v62, v63
    s_waitcnt lgkmcnt(2)
    v_mfma_f32_32x32x16_bf16 v[48:63], v[96:99], v[2:5], v[16:31]
    ds_read_b128 v[100:103], v13 offset:6144
    v_exp_f32 v64, v64
    v_exp_f32 v65, v65
    v_exp_f32 v66, v66
    v_exp_f32 v67, v67
    v_mfma_f32_32x32x16_bf16 v[32:47], v[116:119], v[84:87], v[32:47]
    v_cvt_pk_bf16_f32 v80, v64, v65
    v_exp_f32 v68, v68
    v_exp_f32 v69, v69
    v_cvt_pk_bf16_f32 v81, v66, v67
    v_exp_f32 v70, v70
    v_exp_f32 v71, v71
    v_cvt_pk_bf16_f32 v82, v68, v69
    v_exp_f32 v72, v72
    v_cvt_pk_bf16_f32 v83, v70, v71
    v_exp_f32 v73, v73
    v_exp_f32 v74, v74
    v_mfma_f32_32x32x16_bf16 v[140:155], v[112:115], v[80:83], v[140:155]
    v_exp_f32 v75, v75
    v_cvt_pk_bf16_f32 v84, v72, v73
    v_exp_f32 v76, v76
    v_exp_f32 v77, v77
    v_cvt_pk_bf16_f32 v85, v74, v75
    v_exp_f32 v78, v78
    v_exp_f32 v79, v79
    v_cvt_pk_bf16_f32 v86, v76, v77
    v_cvt_pk_bf16_f32 v87, v78, v79
    v_mfma_f32_32x32x16_bf16 v[64:79], v[96:99], v[120:123], v[124:139]
    v_exp_f32 v48, v48
    v_exp_f32 v49, v49
    v_exp_f32 v50, v50
    v_exp_f32 v51, v51
    v_mfma_f32_32x32x16_bf16 v[140:155], v[116:119], v[84:87], v[140:155]
    s_mov_b64 exec, s[46:47]
    ds_read_b128 v[112:115], v14 offset:6144
    ds_read_b128 v[116:119], v14 offset:6656
    s_mov_b64 exec, -1
    v_cvt_pk_bf16_f32 v80, v48, v49
    v_exp_f32 v52, v52
    v_exp_f32 v53, v53
    v_cvt_pk_bf16_f32 v81, v50, v51
    v_exp_f32 v54, v54
    v_exp_f32 v55, v55
    v_cvt_pk_bf16_f32 v82, v52, v53
    v_exp_f32 v56, v56
    v_cvt_pk_bf16_f32 v83, v54, v55
    v_exp_f32 v57, v57
    v_exp_f32 v58, v58
    s_waitcnt lgkmcnt(3)
    v_mfma_f32_32x32x16_bf16 v[32:47], v[104:107], v[80:83], v[32:47]
    v_exp_f32 v59, v59
    v_cvt_pk_bf16_f32 v84, v56, v57
    v_exp_f32 v60, v60
    v_exp_f32 v61, v61
    v_cvt_pk_bf16_f32 v85, v58, v59
    v_exp_f32 v62, v62
    v_exp_f32 v63, v63
    v_cvt_pk_bf16_f32 v86, v60, v61
    v_cvt_pk_bf16_f32 v87, v62, v63
    s_waitcnt lgkmcnt(2)
    v_mfma_f32_32x32x16_bf16 v[48:63], v[100:103], v[2:5], v[16:31]
    ds_read_b128 v[96:99], v92 offset:0
    v_exp_f32 v64, v64
    v_exp_f32 v65, v65
    v_exp_f32 v66, v66
    v_exp_f32 v67, v67
    v_mfma_f32_32x32x16_bf16 v[32:47], v[108:111], v[84:87], v[32:47]
    v_cvt_pk_bf16_f32 v80, v64, v65
    v_exp_f32 v68, v68
    v_exp_f32 v69, v69
    v_cvt_pk_bf16_f32 v81, v66, v67
    v_exp_f32 v70, v70
    v_exp_f32 v71, v71
    v_cvt_pk_bf16_f32 v82, v68, v69
    v_exp_f32 v72, v72
    v_cvt_pk_bf16_f32 v83, v70, v71
    v_exp_f32 v73, v73
    v_exp_f32 v74, v74
    v_mfma_f32_32x32x16_bf16 v[140:155], v[104:107], v[80:83], v[140:155]
    v_exp_f32 v75, v75
    v_cvt_pk_bf16_f32 v84, v72, v73
    v_exp_f32 v76, v76
    v_exp_f32 v77, v77
    v_cvt_pk_bf16_f32 v85, v74, v75
    v_exp_f32 v78, v78
    v_exp_f32 v79, v79
    v_cvt_pk_bf16_f32 v86, v76, v77
    v_cvt_pk_bf16_f32 v87, v78, v79
    v_mfma_f32_32x32x16_bf16 v[64:79], v[100:103], v[120:123], v[124:139]
    v_exp_f32 v48, v48
    v_exp_f32 v49, v49
    v_exp_f32 v50, v50
    v_exp_f32 v51, v51
    v_mfma_f32_32x32x16_bf16 v[140:155], v[108:111], v[84:87], v[140:155]
    s_mov_b64 exec, s[46:47]
    ds_read_b128 v[104:107], v93 offset:0
    ds_read_b128 v[108:111], v93 offset:512
    s_mov_b64 exec, -1
    v_cvt_pk_bf16_f32 v80, v48, v49
    v_exp_f32 v52, v52
    v_exp_f32 v53, v53
    v_cvt_pk_bf16_f32 v81, v50, v51
    v_exp_f32 v54, v54
    v_exp_f32 v55, v55
    v_cvt_pk_bf16_f32 v82, v52, v53
    v_exp_f32 v56, v56
    v_cvt_pk_bf16_f32 v83, v54, v55
    v_exp_f32 v57, v57
    v_exp_f32 v58, v58
    s_waitcnt lgkmcnt(3)
    v_mfma_f32_32x32x16_bf16 v[32:47], v[112:115], v[80:83], v[32:47]
    v_exp_f32 v59, v59
    v_cvt_pk_bf16_f32 v84, v56, v57
    v_exp_f32 v60, v60
    v_exp_f32 v61, v61
    v_cvt_pk_bf16_f32 v85, v58, v59
    v_exp_f32 v62, v62
    v_exp_f32 v63, v63
    v_cvt_pk_bf16_f32 v86, v60, v61
    v_cvt_pk_bf16_f32 v87, v62, v63
    s_waitcnt lgkmcnt(2)
    v_mfma_f32_32x32x16_bf16 v[48:63], v[96:99], v[2:5], v[16:31]
    ds_read_b128 v[100:103], v92 offset:2048
    v_exp_f32 v64, v64
    v_exp_f32 v65, v65
    v_exp_f32 v66, v66
    v_exp_f32 v67, v67
    v_mfma_f32_32x32x16_bf16 v[32:47], v[116:119], v[84:87], v[32:47]
    v_cvt_pk_bf16_f32 v80, v64, v65
    v_exp_f32 v68, v68
    v_exp_f32 v69, v69
    v_cvt_pk_bf16_f32 v81, v66, v67
    v_exp_f32 v70, v70
    v_exp_f32 v71, v71
    v_cvt_pk_bf16_f32 v82, v68, v69
    v_exp_f32 v72, v72
    v_cvt_pk_bf16_f32 v83, v70, v71
    v_exp_f32 v73, v73
    v_exp_f32 v74, v74
    v_mfma_f32_32x32x16_bf16 v[140:155], v[112:115], v[80:83], v[140:155]
    v_exp_f32 v75, v75
    v_cvt_pk_bf16_f32 v84, v72, v73
    v_exp_f32 v76, v76
    v_exp_f32 v77, v77
    v_cvt_pk_bf16_f32 v85, v74, v75
    v_exp_f32 v78, v78
    v_exp_f32 v79, v79
    v_cvt_pk_bf16_f32 v86, v76, v77
    v_cvt_pk_bf16_f32 v87, v78, v79
    v_mov_b32 v13, v92
    v_mov_b32 v14, v93
    v_add_u32 v92, 16384, v92
    v_add_u32 v93, 16384, v93
    s_add_u32 s62, s62, 1
    s_cmp_lt_u32 s62, 8
    s_cbranch_scc1 L_att_loop_57
    v_mfma_f32_32x32x16_bf16 v[140:155], v[116:119], v[84:87], v[140:155]
    s_mov_b32 s50, 0x80000
L_lw_62:
    ds_read_b32 v10, v8 offset:32
    s_waitcnt lgkmcnt(0)
    v_cmp_ne_u32 vcc, s44, v10
    s_nop 1
    s_cmp_eq_u64 vcc, 0
    s_cbranch_scc1 L_lwd_63
    s_sleep 1
    s_sub_u32 s50, s50, 1
    s_cmp_lg_u32 s50, 0
    s_cbranch_scc1 L_lw_62
L_lwd_63:
    s_mul_i32 s56, s3, 2304
    s_xor_b32 s57, s3, 4
    s_mul_i32 s57, s57, 2304
    v_add_u32 v10, s56, v6
    v_add_u32 v11, s57, v6
    v_lshlrev_b32 v12, 2, v1
    v_add_u32 v9, s57, v12
    v_add_u32 v12, s56, v12
    s_lshl_b32 s56, s3, 2
    s_add_u32 s56, s56, 30784
    s_xor_b32 s57, s56, 16
    s_add_u32 s59, s59, s60
    s_cmp_eq_u32 s60, 0
    s_cbranch_scc0 L_kh1_64
    ds_write_b128 v10, v[140:143]
    ds_write_b128 v10, v[144:147] offset:1024
    ds_write_b32 v12, v148 offset:2048
    s_branch L_khd_65
L_kh1_64:
    ds_write_b128 v10, v[32:35]
    ds_write_b128 v10, v[36:39] offset:1024
    ds_write_b32 v12, v40 offset:2048
    s_nop 0
    v_mov_b32 v32, v140
    v_mov_b32 v33, v141
    v_mov_b32 v34, v142
    v_mov_b32 v35, v143
    v_mov_b32 v36, v144
    v_mov_b32 v37, v145
    v_mov_b32 v38, v146
    v_mov_b32 v39, v147
    v_mov_b32 v40, v148
    v_mov_b32 v2, v120
    v_mov_b32 v3, v121
    v_mov_b32 v4, v122
    v_mov_b32 v5, v123
L_khd_65:
    s_waitcnt lgkmcnt(0)
    v_mov_b32 v13, s44
    v_mov_b32 v14, s56
    s_mov_b64 exec, 1
    ds_write_b32 v14, v13 offset:0
    s_mov_b64 exec, -1
    v_mov_b32 v14, s57
    s_lshl_b32 s56, s59, 15
    s_lshl_b32 s57, s58, 10
    s_add_u32 s56, s56, s57
    s_add_u32 s56, s56, 6291456
    s_lshl_b32 s55, s59, 12
    s_lshl_b32 s57, s58, 7
    s_add_u32 s55, s55, s57
    s_add_u32 s55, s55, 12713984
    s_mov_b32 s50, 0x80000
L_lw_66:
    ds_read_b32 v13, v14 offset:0
    s_waitcnt lgkmcnt(0)
    v_cmp_ne_u32 vcc, s44, v13
    s_nop 1
    s_cmp_eq_u64 vcc, 0
    s_cbranch_scc1 L_lwd_67
    s_sleep 1
    s_sub_u32 s50, s50, 1
    s_cmp_lg_u32 s50, 0
    s_cbranch_scc1 L_lw_66
L_lwd_67:
    ds_read_b128 v[48:51], v11
    ds_read_b128 v[52:55], v11 offset:1024
    ds_read_b32 v56, v9 offset:2048
    v_mov_b32 v10, 1568669696
    s_waitcnt lgkmcnt(0)
    v_add_f32 v32, v32, v48
    v_add_f32 v33, v33, v49
    v_add_f32 v34, v34, v50
    v_add_f32 v35, v35, v51
    v_add_f32 v36, v36, v52
    v_add_f32 v37, v37, v53
    v_add_f32 v38, v38, v54
    v_add_f32 v39, v39, v55
    v_add_f32 v40, v40, v56
    v_fma_f32 v11, v32, 0, v40
    v_fma_f32 v11, v33, 0, v11
    v_fma_f32 v11, v34, 0, v11
    v_fma_f32 v11, v35, 0, v11
    v_fma_f32 v11, v36, 0, v11
    v_fma_f32 v11, v37, 0, v11
    v_fma_f32 v11, v38, 0, v11
    v_fma_f32 v11, v39, 0, v11
    v_cmp_nlt_f32 vcc, v11, v10
    s_nop 1
    s_cmp_eq_u64 vcc, 0
    s_cbranch_scc0 L_att_fb_69
L_att_ok_68:
    v_rcp_f32 v10, v40
    s_nop 0
    v_mul_f32 v32, v32, v10
    v_mul_f32 v33, v33, v10
    v_mul_f32 v34, v34, v10
    v_mul_f32 v35, v35, v10
    v_mul_f32 v36, v36, v10
    v_mul_f32 v37, v37, v10
    v_mul_f32 v38, v38, v10
    v_mul_f32 v39, v39, v10
    v_cvt_pk_bf16_f32 v80, v32, v33
    v_cvt_pk_bf16_f32 v81, v34, v35
    v_cvt_pk_bf16_f32 v82, v36, v37
    v_cvt_pk_bf16_f32 v83, v38, v39
    buffer_store_dwordx4 v[80:83], v6, s[40:43], s56 offen sc1
    s_waitcnt vmcnt(0)
    v_mov_b32 v10, s44
    v_mov_b32 v11, 0
    s_mov_b64 exec, 1
    buffer_store_dword v10, v11, s[40:43], s55 offen sc1
    s_mov_b64 exec, -1
    s_endpgm
L_att_s1_58:
    s_mov_b32 s50, 0x80000
L_lw_70:
    ds_read_b32 v10, v8 offset:0
    s_waitcnt lgkmcnt(0)
    v_cmp_ne_u32 vcc, s44, v10
    s_nop 1
    s_cmp_eq_u64 vcc, 0
    s_cbranch_scc1 L_lwd_71
    s_sleep 1
    s_sub_u32 s50, s50, 1
    s_cmp_lg_u32 s50, 0
    s_cbranch_scc1 L_lw_70
L_lwd_71:
    s_branch L_att_body_61
L_att_s2_59:
    s_mov_b32 s50, 0x80000
L_lw_72:
    ds_read_b32 v10, v8 offset:16
    s_waitcnt lgkmcnt(0)
    v_cmp_ne_u32 vcc, s44, v10
    s_nop 1
    s_cmp_eq_u64 vcc, 0
    s_cbranch_scc1 L_lwd_73
    s_sleep 1
    s_sub_u32 s50, s50, 1
    s_cmp_lg_u32 s50, 0
    s_cbranch_scc1 L_lw_72
L_lwd_73:
    s_setprio 1
    s_branch L_att_body_61
L_att_s3_60:
    s_setprio 0
    v_mov_b32 v92, v13
    v_mov_b32 v93, v14
    s_branch L_att_body_61
L_att_fb_69:
    v_mov_b32 v13, v15
    v_mov_b32 v9, 0xff800000
    s_mov_b32 s62, 0
L_att_mx_74:
    ds_read_b128 v[96:99], v13
    s_waitcnt lgkmcnt(0)
    v_mfma_f32_32x32x16_bf16 v[48:63], v[96:99], v[2:5], 0
    s_nop 11
    v_max3_f32 v11, v48, v49, v50
    v_max3_f32 v11, v11, v51, v52
    v_max3_f32 v11, v11, v53, v54
    v_max3_f32 v11, v11, v55, v56
    v_max3_f32 v11, v11, v57, v58
    v_max3_f32 v11, v11, v59, v60
    v_max3_f32 v11, v11, v61, v62
    v_max_f32 v11, v11, v63
    v_max_f32 v9, v9, v11
    v_add_u32 v13, 2048, v13
    s_add_u32 s62, s62, 1
    s_cmp_lt_u32 s62, 64
    s_cbranch_scc1 L_att_mx_74
    v_mov_b32 v11, v9
    v_mov_b32 v12, v11
    s_nop 1
    v_permlane32_swap_b32 v11, v12
    s_nop 1
    v_max_f32 v11, v11, v12
    v_sub_f32 v16, 0, v11
    v_sub_f32 v17, 0, v11
    v_pk_mov_b32 v[18:19], v[16:17], v[16:17]
    v_pk_mov_b32 v[20:21], v[16:17], v[16:17]
    v_pk_mov_b32 v[22:23], v[16:17], v[16:17]
    v_pk_mov_b32 v[24:25], v[16:17], v[16:17]
    v_pk_mov_b32 v[26:27], v[16:17], v[16:17]
    v_pk_mov_b32 v[28:29], v[16:17], v[16:17]
    v_pk_mov_b32 v[30:31], v[16:17], v[16:17]
    v_mov_b32 v32, 0
    v_mov_b32 v33, 0
    v_mov_b32 v34, 0
    v_mov_b32 v35, 0
    v_mov_b32 v36, 0
    v_mov_b32 v37, 0
    v_mov_b32 v38, 0
    v_mov_b32 v39, 0
    v_mov_b32 v40, 0
    v_mov_b32 v41, 0
    v_mov_b32 v42, 0
    v_mov_b32 v43, 0
    v_mov_b32 v44, 0
    v_mov_b32 v45, 0
    v_mov_b32 v46, 0
    v_mov_b32 v47, 0
    v_mov_b32 v13, v15
    v_mov_b32 v14, v7
    s_mov_b32 s62, 0
L_att_p2_75:
    ds_read_b128 v[96:99], v13
    s_mov_b64 exec, s[46:47]
    ds_read_b128 v[104:107], v14
    ds_read_b128 v[108:111], v14 offset:512
    s_mov_b64 exec, -1
    s_waitcnt lgkmcnt(0)
    v_mfma_f32_32x32x16_bf16 v[48:63], v[96:99], v[2:5], v[16:31]
    s_nop 11
    v_exp_f32 v48, v48
    v_exp_f32 v49, v49
    v_exp_f32 v50, v50
    v_exp_f32 v51, v51
    v_exp_f32 v52, v52
    v_exp_f32 v53, v53
    v_exp_f32 v54, v54
    v_exp_f32 v55, v55
    v_exp_f32 v56, v56
    v_exp_f32 v57, v57
    v_exp_f32 v58, v58
    v_exp_f32 v59, v59
    v_exp_f32 v60, v60
    v_exp_f32 v61, v61
    v_exp_f32 v62, v62
    v_exp_f32 v63, v63
    s_nop 0
    v_cvt_pk_bf16_f32 v80, v48, v49
    v_cvt_pk_bf16_f32 v81, v50, v51
    v_cvt_pk_bf16_f32 v82, v52, v53
    v_cvt_pk_bf16_f32 v83, v54, v55
    v_cvt_pk_bf16_f32 v84, v56, v57
    v_cvt_pk_bf16_f32 v85, v58, v59
    v_cvt_pk_bf16_f32 v86, v60, v61
    v_cvt_pk_bf16_f32 v87, v62, v63
    v_add_u32 v13, 2048, v13
    v_add_u32 v14, 2048, v14
    v_mfma_f32_32x32x16_bf16 v[32:47], v[104:107], v[80:83], v[32:47]
    v_mfma_f32_32x32x16_bf16 v[32:47], v[108:111], v[84:87], v[32:47]
    s_add_u32 s62, s62, 1
    s_cmp_lt_u32 s62, 64
    s_cbranch_scc1 L_att_p2_75
    s_nop 11
    s_branch L_att_ok_68
L_g2_2:
    s_sub_u32 s51, s3, 8
    s_setprio 3
    s_and_b32 s52, s51, 1
    s_lshr_b32 s53, s51, 1
    v_and_b32 v2, 31, v1
    v_lshrrev_b32 v3, 5, v1
    v_and_b32 v4, 15, v1
    s_lshl_b32 s50, s52, 12
    v_lshlrev_b32 v5, 7, v2
    v_add_u32 v5, s50, v5
    v_lshrrev_b32 v7, 1, v4
    v_add_u32 v6, 0, v3
    v_xor_b32 v6, v6, v7
    v_lshlrev_b32 v6, 4, v6
    v_add_u32 v112, v5, v6
    v_add_u32 v116, 65536, v112
    v_add_u32 v120, 131072, v112
    v_add_u32 v6, 2, v3
    v_xor_b32 v6, v6, v7
    v_lshlrev_b32 v6, 4, v6
    v_add_u32 v113, v5, v6
    v_add_u32 v117, 65536, v113
    v_add_u32 v121, 131072, v113
    v_add_u32 v6, 4, v3
    v_xor_b32 v6, v6, v7
    v_lshlrev_b32 v6, 4, v6
    v_add_u32 v114, v5, v6
    v_add_u32 v118, 65536, v114
    v_add_u32 v122, 131072, v114
    v_add_u32 v6, 6, v3
    v_xor_b32 v6, v6, v7
    v_lshlrev_b32 v6, 4, v6
    v_add_u32 v115, v5, v6
    v_add_u32 v119, 65536, v115
    v_add_u32 v123, 131072, v115
    v_mul_u32_u24 v6, 3072, v3
    v_lshrrev_b32 v7, 2, v4
    v_lshlrev_b32 v8, 7, v7
    v_add_u32 v6, v6, v8
    v_lshrrev_b32 v7, 1, v7
    v_xor_b32 v7, s53, v7
    v_lshlrev_b32 v7, 6, v7
    v_add_u32 v6, v6, v7
    v_and_b32 v7, 16, v1
    v_lshlrev_b32 v7, 1, v7
    v_add_u32 v6, v6, v7
    v_and_b32 v7, 3, v1
    v_lshlrev_b32 v7, 3, v7
    v_add_u32 v6, v6, v7
    v_add_u32 v124, 8192, v6
    v_add_u32 v125, 73728, v6
    v_add_u32 v126, 139264, v6
    v_mov_b32 v10, 0
    s_lshl_b32 s54, s6, 1
    s_add_u32 s54, s54, s52
    s_mul_i32 s57, s51, 7680
    v_and_b32 v2, 31, v1
    v_lshrrev_b32 v3, 5, v1
    v_lshlrev_b32 v4, 4, v3
    v_mul_u32_u24 v5, 208, v2
    v_add_u32 v5, v5, v4
    v_add_u32 v136, s57, v5
    v_mul_u32_u24 v5, 212, v2
    v_add_u32 v5, 8, v5
    v_add_u32 v137, s57, v5
    v_mul_u32_u24 v5, 112, v2
    v_add_u32 v5, s57, v5
    v_add_u32 v138, v5, v4
    v_mul_u32_u24 v6, 3584, v3
    v_add_u32 v5, v5, v6
    v_lshlrev_b32 v139, 4, v1
    v_add_u32 v6, 2, v2
    v_lshrrev_b32 v7, 4, v6
    v_lshlrev_b32 v7, 5, v7
    v_and_b32 v8, 4, v6
    v_lshlrev_b32 v8, 2, v8
    v_add_u32 v7, v7, v8
    v_and_b32 v8, 8, v6
    v_add_u32 v7, v7, v8
    v_and_b32 v8, 3, v6
    v_lshlrev_b32 v8, 1, v8
    v_add_u32 v7, v7, v8
    v_add_u32 v128, v5, v7
    v_add_u32 v6, 4, v2
    v_lshrrev_b32 v7, 4, v6
    v_lshlrev_b32 v7, 5, v7
    v_and_b32 v8, 4, v6
    v_lshlrev_b32 v8, 2, v8
    v_add_u32 v7, v7, v8
    v_and_b32 v8, 8, v6
    v_add_u32 v7, v7, v8
    v_and_b32 v8, 3, v6
    v_lshlrev_b32 v8, 1, v8
    v_add_u32 v7, v7, v8
    v_add_u32 v129, v5, v7
    v_add_u32 v6, 6, v2
    v_lshrrev_b32 v7, 4, v6
    v_lshlrev_b32 v7, 5, v7
    v_and_b32 v8, 4, v6
    v_lshlrev_b32 v8, 2, v8
    v_add_u32 v7, v7, v8
    v_and_b32 v8, 8, v6
    v_add_u32 v7, v7, v8
    v_and_b32 v8, 3, v6
    v_lshlrev_b32 v8, 1, v8
    v_add_u32 v7, v7, v8
    v_add_u32 v130, v5, v7
    v_add_u32 v6, 8, v2
    v_lshrrev_b32 v7, 4, v6
    v_lshlrev_b32 v7, 5, v7
    v_and_b32 v8, 4, v6
    v_lshlrev_b32 v8, 2, v8
    v_add_u32 v7, v7, v8
    v_and_b32 v8, 8, v6
    v_add_u32 v7, v7, v8
    v_and_b32 v8, 3, v6
    v_lshlrev_b32 v8, 1, v8
    v_add_u32 v7, v7, v8
    v_add_u32 v131, v5, v7
    v_add_u32 v6, 10, v2
    v_lshrrev_b32 v7, 4, v6
    v_lshlrev_b32 v7, 5, v7
    v_and_b32 v8, 4, v6
    v_lshlrev_b32 v8, 2, v8
    v_add_u32 v7, v7, v8
    v_and_b32 v8, 8, v6
    v_add_u32 v7, v7, v8
    v_and_b32 v8, 3, v6
    v_lshlrev_b32 v8, 1, v8
    v_add_u32 v7, v7, v8
    v_add_u32 v132, v5, v7
    v_add_u32 v6, 12, v2
    v_lshrrev_b32 v7, 4, v6
    v_lshlrev_b32 v7, 5, v7
    v_and_b32 v8, 4, v6
    v_lshlrev_b32 v8, 2, v8
    v_add_u32 v7, v7, v8
    v_and_b32 v8, 8, v6
    v_add_u32 v7, v7, v8
    v_and_b32 v8, 3, v6
    v_lshlrev_b32 v8, 1, v8
    v_add_u32 v7, v7, v8
    v_add_u32 v133, v5, v7
    v_add_u32 v6, 14, v2
    v_lshrrev_b32 v7, 4, v6
    v_lshlrev_b32 v7, 5, v7
    v_and_b32 v8, 4, v6
    v_lshlrev_b32 v8, 2, v8
    v_add_u32 v7, v7, v8
    v_and_b32 v8, 8, v6
    v_add_u32 v7, v7, v8
    v_and_b32 v8, 3, v6
    v_lshlrev_b32 v8, 1, v8
    v_add_u32 v7, v7, v8
    v_add_u32 v134, v5, v7
    v_add_u32 v6, 16, v2
    v_lshrrev_b32 v7, 4, v6
    v_lshlrev_b32 v7, 5, v7
    v_and_b32 v8, 4, v6
    v_lshlrev_b32 v8, 2, v8
    v_add_u32 v7, v7, v8
    v_and_b32 v8, 8, v6
    v_add_u32 v7, v7, v8
    v_and_b32 v8, 3, v6
    v_lshlrev_b32 v8, 1, v8
    v_add_u32 v7, v7, v8
    v_add_u32 v135, v5, v7
    s_lshl_b32 s55, s7, 1
    s_add_u32 s55, s55, s53
    s_lshl_b32 s56, s6, 4
    s_add_u32 s56, s56, s55
    s_lshl_b32 s58, s56, 12
    s_add_u32 s58, s58, 10485760
    s_lshl_b32 s59, s56, 7
    s_add_u32 s59, s59, 13107200
    s_lshl_b32 s60, s53, 2
    s_add_u32 s60, s60, 30832
    s_waitcnt lgkmcnt(0)
    s_mov_b64 s[8:9], s[64:65]
    s_mov_b64 s[12:13], s[66:67]
    s_mov_b64 s[16:17], s[68:69]
    s_mov_b64 s[20:21], s[70:71]
    s_mov_b64 s[24:25], s[72:73]
    s_mov_b64 s[28:29], s[74:75]
    s_mov_b64 s[32:33], s[76:77]
    s_mov_b64 s[36:37], s[78:79]
    s_mov_b64 s[40:41], s[80:81]
    s_barrier
    s_barrier
    s_barrier
    s_barrier
    s_barrier
    s_barrier
    s_barrier
    s_barrier
    s_barrier
    ds_read_b128 v[64:67], v116 offset:32768
    ds_read_b64_tr_b16 v[68:69], v125 offset:32768
    ds_read_b64_tr_b16 v[70:71], v125 offset:33280
    ds_read_b64_tr_b16 v[72:73], v125 offset:33792
    ds_read_b64_tr_b16 v[74:75], v125 offset:34304
    ds_read_b64_tr_b16 v[76:77], v125 offset:34816
    ds_read_b64_tr_b16 v[78:79], v125 offset:35328
    ds_read_b128 v[80:83], v117 offset:32768
    ds_read_b64_tr_b16 v[84:85], v125 offset:38912
    ds_read_b64_tr_b16 v[86:87], v125 offset:39424
    ds_read_b64_tr_b16 v[88:89], v125 offset:39936
    ds_read_b64_tr_b16 v[90:91], v125 offset:40448
    ds_read_b64_tr_b16 v[92:93], v125 offset:40960
    ds_read_b64_tr_b16 v[94:95], v125 offset:41472
    s_waitcnt lgkmcnt(7)
    v_mfma_f32_32x32x16_bf16 v[32:47], v[72:75], v[64:67], 0
    ds_read_b128 v[96:99], v118 offset:32768
    ds_read_b64_tr_b16 v[100:101], v125 offset:45056
    ds_read_b64_tr_b16 v[102:103], v125 offset:45568
    v_mfma_f32_32x32x16_bf16 v[48:63], v[64:67], v[76:79], 0
    ds_read_b64_tr_b16 v[104:105], v125 offset:46080
    ds_read_b64_tr_b16 v[106:107], v125 offset:46592
    v_mfma_f32_32x32x16_bf16 v[16:31], v[68:71], v[64:67], 0
    ds_read_b64_tr_b16 v[108:109], v125 offset:47104
    ds_read_b64_tr_b16 v[110:111], v125 offset:47616
    s_waitcnt lgkmcnt(7)
    v_mfma_f32_32x32x16_bf16 v[32:47], v[88:91], v[80:83], v[32:47]
    ds_read_b128 v[64:67], v119 offset:32768
    ds_read_b64_tr_b16 v[68:69], v125 offset:51200
    ds_read_b64_tr_b16 v[70:71], v125 offset:51712
    v_mfma_f32_32x32x16_bf16 v[48:63], v[80:83], v[92:95], v[48:63]
    ds_read_b64_tr_b16 v[72:73], v125 offset:52224
    ds_read_b64_tr_b16 v[74:75], v125 offset:52736
    v_mfma_f32_32x32x16_bf16 v[16:31], v[84:87], v[80:83], v[16:31]
    ds_read_b64_tr_b16 v[76:77], v125 offset:53248
    ds_read_b64_tr_b16 v[78:79], v125 offset:53760
    s_waitcnt lgkmcnt(7)
    v_mfma_f32_32x32x16_bf16 v[32:47], v[104:107], v[96:99], v[32:47]
    s_barrier
    ds_read_b128 v[80:83], v120 offset:0
    ds_read_b64_tr_b16 v[84:85], v126 offset:0
    ds_read_b64_tr_b16 v[86:87], v126 offset:512
    v_mfma_f32_32x32x16_bf16 v[48:63], v[96:99], v[108:111], v[48:63]
    ds_read_b64_tr_b16 v[88:89], v126 offset:1024
    ds_read_b64_tr_b16 v[90:91], v126 offset:1536
    v_mfma_f32_32x32x16_bf16 v[16:31], v[100:103], v[96:99], v[16:31]
    ds_read_b64_tr_b16 v[92:93], v126 offset:2048
    ds_read_b64_tr_b16 v[94:95], v126 offset:2560
    s_waitcnt lgkmcnt(7)
    v_mfma_f32_32x32x16_bf16 v[32:47], v[72:75], v[64:67], v[32:47]
    ds_read_b128 v[96:99], v121 offset:0
    ds_read_b64_tr_b16 v[100:101], v126 offset:6144
    ds_read_b64_tr_b16 v[102:103], v126 offset:6656
    v_mfma_f32_32x32x16_bf16 v[48:63], v[64:67], v[76:79], v[48:63]
    ds_read_b64_tr_b16 v[104:105], v126 offset:7168
    ds_read_b64_tr_b16 v[106:107], v126 offset:7680
    v_mfma_f32_32x32x16_bf16 v[16:31], v[68:71], v[64:67], v[16:31]
    ds_read_b64_tr_b16 v[108:109], v126 offset:8192
    ds_read_b64_tr_b16 v[110:111], v126 offset:8704
    s_waitcnt lgkmcnt(7)
    v_mfma_f32_32x32x16_bf16 v[32:47], v[88:91], v[80:83], v[32:47]
    ds_read_b128 v[64:67], v122 offset:0
    ds_read_b64_tr_b16 v[68:69], v126 offset:12288
    ds_read_b64_tr_b16 v[70:71], v126 offset:12800
    v_mfma_f32_32x32x16_bf16 v[48:63], v[80:83], v[92:95], v[48:63]
    ds_read_b64_tr_b16 v[72:73], v126 offset:13312
    ds_read_b64_tr_b16 v[74:75], v126 offset:13824
    v_mfma_f32_32x32x16_bf16 v[16:31], v[84:87], v[80:83], v[16:31]
    ds_read_b64_tr_b16 v[76:77], v126 offset:14336
    ds_read_b64_tr_b16 v[78:79], v126 offset:14848
    s_waitcnt lgkmcnt(7)
    v_mfma_f32_32x32x16_bf16 v[32:47], v[104:107], v[96:99], v[32:47]
    ds_read_b128 v[80:83], v123 offset:0
    ds_read_b64_tr_b16 v[84:85], v126 offset:18432
    ds_read_b64_tr_b16 v[86:87], v126 offset:18944
    v_mfma_f32_32x32x16_bf16 v[48:63], v[96:99], v[108:111], v[48:63]
    ds_read_b64_tr_b16 v[88:89], v126 offset:19456
    ds_read_b64_tr_b16 v[90:91], v126 offset:19968
    v_mfma_f32_32x32x16_bf16 v[16:31], v[100:103], v[96:99], v[16:31]
    ds_read_b64_tr_b16 v[92:93], v126 offset:20480
    ds_read_b64_tr_b16 v[94:95], v126 offset:20992
    s_waitcnt lgkmcnt(7)
    v_mfma_f32_32x32x16_bf16 v[32:47], v[72:75], v[64:67], v[32:47]
    s_barrier
    ds_read_b128 v[96:99], v112 offset:0
    ds_read_b64_tr_b16 v[100:101], v124 offset:0
    ds_read_b64_tr_b16 v[102:103], v124 offset:512
    v_mfma_f32_32x32x16_bf16 v[48:63], v[64:67], v[76:79], v[48:63]
    ds_read_b64_tr_b16 v[104:105], v124 offset:1024
    ds_read_b64_tr_b16 v[106:107], v124 offset:1536
    v_mfma_f32_32x32x16_bf16 v[16:31], v[68:71], v[64:67], v[16:31]
    ds_read_b64_tr_b16 v[108:109], v124 offset:2048
    ds_read_b64_tr_b16 v[110:111], v124 offset:2560
    s_waitcnt lgkmcnt(7)
    v_mfma_f32_32x32x16_bf16 v[32:47], v[88:91], v[80:83], v[32:47]
    ds_read_b128 v[64:67], v113 offset:0
    ds_read_b64_tr_b16 v[68:69], v124 offset:6144
    ds_read_b64_tr_b16 v[70:71], v124 offset:6656
    v_mfma_f32_32x32x16_bf16 v[48:63], v[80:83], v[92:95], v[48:63]
    ds_read_b64_tr_b16 v[72:73], v124 offset:7168
    ds_read_b64_tr_b16 v[74:75], v124 offset:7680
    v_mfma_f32_32x32x16_bf16 v[16:31], v[84:87], v[80:83], v[16:31]
    ds_read_b64_tr_b16 v[76:77], v124 offset:8192
    ds_read_b64_tr_b16 v[78:79], v124 offset:8704
    s_waitcnt lgkmcnt(7)
    v_mfma_f32_32x32x16_bf16 v[32:47], v[104:107], v[96:99], v[32:47]
    ds_read_b128 v[80:83], v114 offset:0
    ds_read_b64_tr_b16 v[84:85], v124 offset:12288
    ds_read_b64_tr_b16 v[86:87], v124 offset:12800
    v_mfma_f32_32x32x16_bf16 v[48:63], v[96:99], v[108:111], v[48:63]
    ds_read_b64_tr_b16 v[88:89], v124 offset:13312
    ds_read_b64_tr_b16 v[90:91], v124 offset:13824
    v_mfma_f32_32x32x16_bf16 v[16:31], v[100:103], v[96:99], v[16:31]
    ds_read_b64_tr_b16 v[92:93], v124 offset:14336
    ds_read_b64_tr_b16 v[94:95], v124 offset:14848
    s_waitcnt lgkmcnt(7)
    v_mfma_f32_32x32x16_bf16 v[32:47], v[72:75], v[64:67], v[32:47]
    ds_read_b128 v[96:99], v115 offset:0
    ds_read_b64_tr_b16 v[100:101], v124 offset:18432
    ds_read_b64_tr_b16 v[102:103], v124 offset:18944
    v_mfma_f32_32x32x16_bf16 v[48:63], v[64:67], v[76:79], v[48:63]
    ds_read_b64_tr_b16 v[104:105], v124 offset:19456
    ds_read_b64_tr_b16 v[106:107], v124 offset:19968
    v_mfma_f32_32x32x16_bf16 v[16:31], v[68:71], v[64:67], v[16:31]
    ds_read_b64_tr_b16 v[108:109], v124 offset:20480
    ds_read_b64_tr_b16 v[110:111], v124 offset:20992
    s_waitcnt lgkmcnt(7)
    v_mfma_f32_32x32x16_bf16 v[32:47], v[88:91], v[80:83], v[32:47]
    s_barrier
    ds_read_b128 v[64:67], v112 offset:32768
    ds_read_b64_tr_b16 v[68:69], v124 offset:32768
    ds_read_b64_tr_b16 v[70:71], v124 offset:33280
    v_mfma_f32_32x32x16_bf16 v[48:63], v[80:83], v[92:95], v[48:63]
    ds_read_b64_tr_b16 v[72:73], v124 offset:33792
    ds_read_b64_tr_b16 v[74:75], v124 offset:34304
    v_mfma_f32_32x32x16_bf16 v[16:31], v[84:87], v[80:83], v[16:31]
    ds_read_b64_tr_b16 v[76:77], v124 offset:34816
    ds_read_b64_tr_b16 v[78:79], v124 offset:35328
    s_waitcnt lgkmcnt(7)
    v_mfma_f32_32x32x16_bf16 v[32:47], v[104:107], v[96:99], v[32:47]
    ds_read_b128 v[80:83], v113 offset:32768
    ds_read_b64_tr_b16 v[84:85], v124 offset:38912
    ds_read_b64_tr_b16 v[86:87], v124 offset:39424
    v_mfma_f32_32x32x16_bf16 v[48:63], v[96:99], v[108:111], v[48:63]
    ds_read_b64_tr_b16 v[88:89], v124 offset:39936
    ds_read_b64_tr_b16 v[90:91], v124 offset:40448
    v_mfma_f32_32x32x16_bf16 v[16:31], v[100:103], v[96:99], v[16:31]
    ds_read_b64_tr_b16 v[92:93], v124 offset:40960
    ds_read_b64_tr_b16 v[94:95], v124 offset:41472
    s_waitcnt lgkmcnt(7)
    v_mfma_f32_32x32x16_bf16 v[32:47], v[72:75], v[64:67], v[32:47]
    buffer_load_dword v9, v10, s[36:39], 0 offen sc1
    ds_read_b128 v[96:99], v114 offset:32768
    ds_read_b64_tr_b16 v[100:101], v124 offset:45056
    ds_read_b64_tr_b16 v[102:103], v124 offset:45568
    v_mfma_f32_32x32x16_bf16 v[48:63], v[64:67], v[76:79], v[48:63]
    ds_read_b64_tr_b16 v[104:105], v124 offset:46080
    ds_read_b64_tr_b16 v[106:107], v124 offset:46592
    v_mfma_f32_32x32x16_bf16 v[16:31], v[68:71], v[64:67], v[16:31]
    ds_read_b64_tr_b16 v[108:109], v124 offset:47104
    ds_read_b64_tr_b16 v[110:111], v124 offset:47616
    s_waitcnt lgkmcnt(7)
    v_mfma_f32_32x32x16_bf16 v[32:47], v[88:91], v[80:83], v[32:47]
    ds_read_b128 v[64:67], v115 offset:32768
    ds_read_b64_tr_b16 v[68:69], v124 offset:51200
    ds_read_b64_tr_b16 v[70:71], v124 offset:51712
    v_mfma_f32_32x32x16_bf16 v[48:63], v[80:83], v[92:95], v[48:63]
    ds_read_b64_tr_b16 v[72:73], v124 offset:52224
    ds_read_b64_tr_b16 v[74:75], v124 offset:52736
    v_mfma_f32_32x32x16_bf16 v[16:31], v[84:87], v[80:83], v[16:31]
    ds_read_b64_tr_b16 v[76:77], v124 offset:53248
    ds_read_b64_tr_b16 v[78:79], v124 offset:53760
    s_waitcnt lgkmcnt(7)
    v_mfma_f32_32x32x16_bf16 v[32:47], v[104:107], v[96:99], v[32:47]
    s_barrier
    ds_read_b128 v[80:83], v116 offset:0
    ds_read_b64_tr_b16 v[84:85], v125 offset:0
    ds_read_b64_tr_b16 v[86:87], v125 offset:512
    v_mfma_f32_32x32x16_bf16 v[48:63], v[96:99], v[108:111], v[48:63]
    ds_read_b64_tr_b16 v[88:89], v125 offset:1024
    ds_read_b64_tr_b16 v[90:91], v125 offset:1536
    v_mfma_f32_32x32x16_bf16 v[16:31], v[100:103], v[96:99], v[16:31]
    ds_read_b64_tr_b16 v[92:93], v125 offset:2048
    ds_read_b64_tr_b16 v[94:95], v125 offset:2560
    s_waitcnt lgkmcnt(7)
    v_mfma_f32_32x32x16_bf16 v[32:47], v[72:75], v[64:67], v[32:47]
    ds_read_b128 v[96:99], v117 offset:0
    ds_read_b64_tr_b16 v[100:101], v125 offset:6144
    ds_read_b64_tr_b16 v[102:103], v125 offset:6656
    v_mfma_f32_32x32x16_bf16 v[48:63], v[64:67], v[76:79], v[48:63]
    ds_read_b64_tr_b16 v[104:105], v125 offset:7168
    ds_read_b64_tr_b16 v[106:107], v125 offset:7680
    v_mfma_f32_32x32x16_bf16 v[16:31], v[68:71], v[64:67], v[16:31]
    ds_read_b64_tr_b16 v[108:109], v125 offset:8192
    ds_read_b64_tr_b16 v[110:111], v125 offset:8704
    s_waitcnt lgkmcnt(7)
    v_mfma_f32_32x32x16_bf16 v[32:47], v[88:91], v[80:83], v[32:47]
    ds_read_b128 v[64:67], v118 offset:0
    ds_read_b64_tr_b16 v[68:69], v125 offset:12288
    ds_read_b64_tr_b16 v[70:71], v125 offset:12800
    v_mfma_f32_32x32x16_bf16 v[48:63], v[80:83], v[92:95], v[48:63]
    ds_read_b64_tr_b16 v[72:73], v125 offset:13312
    ds_read_b64_tr_b16 v[74:75], v125 offset:13824
    v_mfma_f32_32x32x16_bf16 v[16:31], v[84:87], v[80:83], v[16:31]
    ds_read_b64_tr_b16 v[76:77], v125 offset:14336
    ds_read_b64_tr_b16 v[78:79], v125 offset:14848
    s_waitcnt lgkmcnt(7)
    v_mfma_f32_32x32x16_bf16 v[32:47], v[104:107], v[96:99], v[32:47]
    ds_read_b128 v[80:83], v119 offset:0
    ds_read_b64_tr_b16 v[84:85], v125 offset:18432
    ds_read_b64_tr_b16 v[86:87], v125 offset:18944
    v_mfma_f32_32x32x16_bf16 v[48:63], v[96:99], v[108:111], v[48:63]
    ds_read_b64_tr_b16 v[88:89], v125 offset:19456
    ds_read_b64_tr_b16 v[90:91], v125 offset:19968
    v_mfma_f32_32x32x16_bf16 v[16:31], v[100:103], v[96:99], v[16:31]
    ds_read_b64_tr_b16 v[92:93], v125 offset:20480
    ds_read_b64_tr_b16 v[94:95], v125 offset:20992
    s_waitcnt lgkmcnt(7)
    v_mfma_f32_32x32x16_bf16 v[32:47], v[72:75], v[64:67], v[32:47]
    s_barrier
    ds_read_b128 v[96:99], v116 offset:32768
    ds_read_b64_tr_b16 v[100:101], v125 offset:32768
    ds_read_b64_tr_b16 v[102:103], v125 offset:33280
    v_mfma_f32_32x32x16_bf16 v[48:63], v[64:67], v[76:79], v[48:63]
    ds_read_b64_tr_b16 v[104:105], v125 offset:33792
    ds_read_b64_tr_b16 v[106:107], v125 offset:34304
    v_mfma_f32_32x32x16_bf16 v[16:31], v[68:71], v[64:67], v[16:31]
    ds_read_b64_tr_b16 v[108:109], v125 offset:34816
    ds_read_b64_tr_b16 v[110:111], v125 offset:35328
    s_waitcnt lgkmcnt(7)
    v_mfma_f32_32x32x16_bf16 v[32:47], v[88:91], v[80:83], v[32:47]
    ds_read_b128 v[64:67], v117 offset:32768
    ds_read_b64_tr_b16 v[68:69], v125 offset:38912
    ds_read_b64_tr_b16 v[70:71], v125 offset:39424
    v_mfma_f32_32x32x16_bf16 v[48:63], v[80:83], v[92:95], v[48:63]
    ds_read_b64_tr_b16 v[72:73], v125 offset:39936
    ds_read_b64_tr_b16 v[74:75], v125 offset:40448
    v_mfma_f32_32x32x16_bf16 v[16:31], v[84:87], v[80:83], v[16:31]
    ds_read_b64_tr_b16 v[76:77], v125 offset:40960
    ds_read_b64_tr_b16 v[78:79], v125 offset:41472
    s_waitcnt lgkmcnt(7)
    v_mfma_f32_32x32x16_bf16 v[32:47], v[104:107], v[96:99], v[32:47]
    ds_read_b128 v[80:83], v118 offset:32768
    ds_read_b64_tr_b16 v[84:85], v125 offset:45056
    ds_read_b64_tr_b16 v[86:87], v125 offset:45568
    v_mfma_f32_32x32x16_bf16 v[48:63], v[96:99], v[108:111], v[48:63]
    ds_read_b64_tr_b16 v[88:89], v125 offset:46080
    ds_read_b64_tr_b16 v[90:91], v125 offset:46592
    v_mfma_f32_32x32x16_bf16 v[16:31], v[100:103], v[96:99], v[16:31]
    ds_read_b64_tr_b16 v[92:93], v125 offset:47104
    ds_read_b64_tr_b16 v[94:95], v125 offset:47616
    s_waitcnt lgkmcnt(7)
    v_mfma_f32_32x32x16_bf16 v[32:47], v[72:75], v[64:67], v[32:47]
    ds_read_b128 v[96:99], v119 offset:32768
    ds_read_b64_tr_b16 v[100:101], v125 offset:51200
    ds_read_b64_tr_b16 v[102:103], v125 offset:51712
    v_mfma_f32_32x32x16_bf16 v[48:63], v[64:67], v[76:79], v[48:63]
    ds_read_b64_tr_b16 v[104:105], v125 offset:52224
    ds_read_b64_tr_b16 v[106:107], v125 offset:52736
    v_mfma_f32_32x32x16_bf16 v[16:31], v[68:71], v[64:67], v[16:31]
    ds_read_b64_tr_b16 v[108:109], v125 offset:53248
    ds_read_b64_tr_b16 v[110:111], v125 offset:53760
    s_waitcnt lgkmcnt(7)
    v_mfma_f32_32x32x16_bf16 v[32:47], v[88:91], v[80:83], v[32:47]
    s_barrier
    ds_read_b128 v[64:67], v120 offset:0
    ds_read_b64_tr_b16 v[68:69], v126 offset:0
    ds_read_b64_tr_b16 v[70:71], v126 offset:512
    v_mfma_f32_32x32x16_bf16 v[48:63], v[80:83], v[92:95], v[48:63]
    ds_read_b64_tr_b16 v[72:73], v126 offset:1024
    ds_read_b64_tr_b16 v[74:75], v126 offset:1536
    v_mfma_f32_32x32x16_bf16 v[16:31], v[84:87], v[80:83], v[16:31]
    ds_read_b64_tr_b16 v[76:77], v126 offset:2048
    ds_read_b64_tr_b16 v[78:79], v126 offset:2560
    s_waitcnt lgkmcnt(7)
    v_mfma_f32_32x32x16_bf16 v[32:47], v[104:107], v[96:99], v[32:47]
    ds_read_b128 v[80:83], v121 offset:0
    ds_read_b64_tr_b16 v[84:85], v126 offset:6144
    ds_read_b64_tr_b16 v[86:87], v126 offset:6656
    v_mfma_f32_32x32x16_bf16 v[48:63], v[96:99], v[108:111], v[48:63]
    ds_read_b64_tr_b16 v[88:89], v126 offset:7168
    ds_read_b64_tr_b16 v[90:91], v126 offset:7680
    v_mfma_f32_32x32x16_bf16 v[16:31], v[100:103], v[96:99], v[16:31]
    ds_read_b64_tr_b16 v[92:93], v126 offset:8192
    ds_read_b64_tr_b16 v[94:95], v126 offset:8704
    s_waitcnt lgkmcnt(7)
    v_mfma_f32_32x32x16_bf16 v[32:47], v[72:75], v[64:67], v[32:47]
    ds_read_b128 v[96:99], v122 offset:0
    ds_read_b64_tr_b16 v[100:101], v126 offset:12288
    ds_read_b64_tr_b16 v[102:103], v126 offset:12800
    v_mfma_f32_32x32x16_bf16 v[48:63], v[64:67], v[76:79], v[48:63]
    ds_read_b64_tr_b16 v[104:105], v126 offset:13312
    ds_read_b64_tr_b16 v[106:107], v126 offset:13824
    v_mfma_f32_32x32x16_bf16 v[16:31], v[68:71], v[64:67], v[16:31]
    ds_read_b64_tr_b16 v[108:109], v126 offset:14336
    ds_read_b64_tr_b16 v[110:111], v126 offset:14848
    s_waitcnt lgkmcnt(7)
    v_mfma_f32_32x32x16_bf16 v[32:47], v[88:91], v[80:83], v[32:47]
    ds_read_b128 v[64:67], v123 offset:0
    ds_read_b64_tr_b16 v[68:69], v126 offset:18432
    ds_read_b64_tr_b16 v[70:71], v126 offset:18944
    v_mfma_f32_32x32x16_bf16 v[48:63], v[80:83], v[92:95], v[48:63]
    ds_read_b64_tr_b16 v[72:73], v126 offset:19456
    ds_read_b64_tr_b16 v[74:75], v126 offset:19968
    v_mfma_f32_32x32x16_bf16 v[16:31], v[84:87], v[80:83], v[16:31]
    ds_read_b64_tr_b16 v[76:77], v126 offset:20480
    ds_read_b64_tr_b16 v[78:79], v126 offset:20992
    s_waitcnt lgkmcnt(7)
    v_mfma_f32_32x32x16_bf16 v[32:47], v[104:107], v[96:99], v[32:47]
    s_barrier
    ds_read_b128 v[80:83], v112 offset:0
    ds_read_b64_tr_b16 v[84:85], v124 offset:0
    ds_read_b64_tr_b16 v[86:87], v124 offset:512
    v_mfma_f32_32x32x16_bf16 v[48:63], v[96:99], v[108:111], v[48:63]
    ds_read_b64_tr_b16 v[88:89], v124 offset:1024
    ds_read_b64_tr_b16 v[90:91], v124 offset:1536
    v_mfma_f32_32x32x16_bf16 v[16:31], v[100:103], v[96:99], v[16:31]
    ds_read_b64_tr_b16 v[92:93], v124 offset:2048
    ds_read_b64_tr_b16 v[94:95], v124 offset:2560
    s_waitcnt lgkmcnt(7)
    v_mfma_f32_32x32x16_bf16 v[32:47], v[72:75], v[64:67], v[32:47]
    ds_read_b128 v[96:99], v113 offset:0
    ds_read_b64_tr_b16 v[100:101], v124 offset:6144
    ds_read_b64_tr_b16 v[102:103], v124 offset:6656
    v_mfma_f32_32x32x16_bf16 v[48:63], v[64:67], v[76:79], v[48:63]
    ds_read_b64_tr_b16 v[104:105], v124 offset:7168
    ds_read_b64_tr_b16 v[106:107], v124 offset:7680
    v_mfma_f32_32x32x16_bf16 v[16:31], v[68:71], v[64:67], v[16:31]
    ds_read_b64_tr_b16 v[108:109], v124 offset:8192
    ds_read_b64_tr_b16 v[110:111], v124 offset:8704
    s_waitcnt lgkmcnt(7)
    v_mfma_f32_32x32x16_bf16 v[32:47], v[88:91], v[80:83], v[32:47]
    ds_read_b128 v[64:67], v114 offset:0
    ds_read_b64_tr_b16 v[68:69], v124 offset:12288
    ds_read_b64_tr_b16 v[70:71], v124 offset:12800
    v_mfma_f32_32x32x16_bf16 v[48:63], v[80:83], v[92:95], v[48:63]
    ds_read_b64_tr_b16 v[72:73], v124 offset:13312
    ds_read_b64_tr_b16 v[74:75], v124 offset:13824
    v_mfma_f32_32x32x16_bf16 v[16:31], v[84:87], v[80:83], v[16:31]
    ds_read_b64_tr_b16 v[76:77], v124 offset:14336
    ds_read_b64_tr_b16 v[78:79], v124 offset:14848
    s_waitcnt lgkmcnt(7)
    v_mfma_f32_32x32x16_bf16 v[32:47], v[104:107], v[96:99], v[32:47]
    ds_read_b128 v[80:83], v115 offset:0
    ds_read_b64_tr_b16 v[84:85], v124 offset:18432
    ds_read_b64_tr_b16 v[86:87], v124 offset:18944
    v_mfma_f32_32x32x16_bf16 v[48:63], v[96:99], v[108:111], v[48:63]
    ds_read_b64_tr_b16 v[88:89], v124 offset:19456
    ds_read_b64_tr_b16 v[90:91], v124 offset:19968
    v_mfma_f32_32x32x16_bf16 v[16:31], v[100:103], v[96:99], v[16:31]
    ds_read_b64_tr_b16 v[92:93], v124 offset:20480
    ds_read_b64_tr_b16 v[94:95], v124 offset:20992
    s_waitcnt lgkmcnt(7)
    v_mfma_f32_32x32x16_bf16 v[32:47], v[72:75], v[64:67], v[32:47]
    v_mfma_f32_32x32x16_bf16 v[48:63], v[64:67], v[76:79], v[48:63]
    v_mfma_f32_32x32x16_bf16 v[16:31], v[68:71], v[64:67], v[16:31]
    s_waitcnt lgkmcnt(0)
    s_barrier
    v_mfma_f32_32x32x16_bf16 v[32:47], v[88:91], v[80:83], v[32:47]
    v_mfma_f32_32x32x16_bf16 v[48:63], v[80:83], v[92:95], v[48:63]
    v_mfma_f32_32x32x16_bf16 v[16:31], v[84:87], v[80:83], v[16:31]
    s_waitcnt vmcnt(0)
    s_mov_b32 s50, 30000
L_gt_76:
    v_readfirstlane_b32 s44, v9
    s_nop 1
    s_cmp_lg_u32 s44, 0
    s_cbranch_scc1 L_gtd_77
    s_sleep 4
    buffer_load_dword v9, v10, s[36:39], 0 offen sc1
    s_sub_u32 s50, s50, 1
    s_cmp_lg_u32 s50, 0
    s_waitcnt vmcnt(0)
    s_cbranch_scc1 L_gt_76
L_gtd_77:
    s_nop 3
    v_cvt_pk_bf16_f32 v72, v32, v33
    v_cvt_pk_bf16_f32 v73, v34, v35
    v_cvt_pk_bf16_f32 v74, v36, v37
    v_cvt_pk_bf16_f32 v75, v38, v39
    v_cvt_pk_bf16_f32 v76, v40, v41
    v_cvt_pk_bf16_f32 v77, v42, v43
    v_cvt_pk_bf16_f32 v78, v44, v45
    v_cvt_pk_bf16_f32 v79, v46, v47
    v_cvt_pk_bf16_f32 v80, v48, v49
    v_cvt_pk_bf16_f32 v81, v50, v51
    v_cvt_pk_bf16_f32 v82, v52, v53
    v_cvt_pk_bf16_f32 v83, v54, v55
    v_cvt_pk_bf16_f32 v84, v56, v57
    v_cvt_pk_bf16_f32 v85, v58, v59
    v_cvt_pk_bf16_f32 v86, v60, v61
    v_cvt_pk_bf16_f32 v87, v62, v63
    s_cmp_lg_u32 s52, 1
    s_cbranch_scc1 L_nohs_78
    buffer_store_dwordx4 v[72:75], v139, s[40:43], s58 offen offset:0 sc1
    buffer_store_dwordx4 v[76:79], v139, s[40:43], s58 offen offset:1024 sc1
    buffer_store_dwordx4 v[84:87], v139, s[40:43], s58 offen offset:2048 sc1
    s_branch L_hsd_79
L_nohs_78:
    s_add_u32 s50, s57, 7680
    v_add_u32 v4, s50, v139
    ds_write_b128 v4, v[72:75] offset:0
    ds_write_b128 v4, v[76:79] offset:1024
    ds_write_b128 v4, v[84:87] offset:2048
    s_waitcnt lgkmcnt(0)
    v_mov_b32 v6, s44
    v_mov_b32 v7, s60
    s_mov_b64 exec, 1
    ds_write_b32 v7, v6 offset:0
    s_mov_b64 exec, -1
L_hsd_79:
    v_cvt_pk_bf16_f32 v64, v16, v17
    v_cvt_pk_bf16_f32 v65, v18, v19
    v_cvt_pk_bf16_f32 v66, v20, v21
    v_cvt_pk_bf16_f32 v67, v22, v23
    v_cvt_pk_bf16_f32 v68, v24, v25
    v_cvt_pk_bf16_f32 v69, v26, v27
    v_cvt_pk_bf16_f32 v70, v28, v29
    v_cvt_pk_bf16_f32 v71, v30, v31
    s_lshl_b32 s61, s4, 2
    s_and_b32 s50, s5, 3
    s_add_u32 s61, s61, s50
    v_lshlrev_b32 v10, 4, v1
    s_lshl_b32 s62, s51, 2
    s_add_u32 s62, s62, 30720
    v_and_b32 v11, 3, v1
    v_lshlrev_b32 v11, 2, v11
    v_add_u32 v11, 30720, v11
    s_mov_b32 s63, s55
    s_mov_b32 s53, s57
    v_mov_b32 v13, 30768
    s_mov_b32 s50, 0x80000
L_lw_80:
    ds_read_b32 v12, v13 offset:0
    s_waitcnt lgkmcnt(0)
    v_cmp_ne_u32 vcc, s44, v12
    s_nop 1
    s_cmp_eq_u64 vcc, 0
    s_cbranch_scc1 L_lwd_81
    s_sleep 1
    s_sub_u32 s50, s50, 1
    s_cmp_lg_u32 s50, 0
    s_cbranch_scc1 L_lw_80
L_lwd_81:
    s_lshl_b32 s56, s61, 17
    s_mul_i32 s57, s51, 12288
    s_add_u32 s57, s57, 32768
    s_add_u32 s56, s56, s57
    s_add_u32 s56, s56, 2097152
    s_add_u32 m0, s57, 32768
    s_add_u32 s55, s56, 0
    buffer_load_dwordx4 v10, s[40:43], s55 offen offset:0 sc1 lds
    buffer_load_dwordx4 v10, s[40:43], s55 offen offset:1024 sc1 lds
    buffer_load_dwordx4 v10, s[40:43], s55 offen offset:2048 sc1 lds
    buffer_load_dwordx4 v10, s[40:43], s55 offen offset:3072 sc1 lds
    s_add_u32 m0, s57, 36864
    s_add_u32 s55, s56, 4096
    buffer_load_dwordx4 v10, s[40:43], s55 offen offset:0 sc1 lds
    buffer_load_dwordx4 v10, s[40:43], s55 offen offset:1024 sc1 lds
    buffer_load_dwordx4 v10, s[40:43], s55 offen offset:2048 sc1 lds
    buffer_load_dwordx4 v10, s[40:43], s55 offen offset:3072 sc1 lds
    s_add_u32 m0, s57, 40960
    s_add_u32 s55, s56, 8192
    buffer_load_dwordx4 v10, s[40:43], s55 offen offset:0 sc1 lds
    buffer_load_dwordx4 v10, s[40:43], s55 offen offset:1024 sc1 lds
    buffer_load_dwordx4 v10, s[40:43], s55 offen offset:2048 sc1 lds
    buffer_load_dwordx4 v10, s[40:43], s55 offen offset:3072 sc1 lds
    s_lshl_b32 s56, s61, 17
    s_mul_i32 s57, s51, 12288
    s_add_u32 s57, s57, 81920
    s_add_u32 s56, s56, s57
    s_add_u32 s56, s56, 2097152
    s_add_u32 m0, s57, 32768
    s_add_u32 s55, s56, 0
    buffer_load_dwordx4 v10, s[40:43], s55 offen offset:0 sc1 lds
    buffer_load_dwordx4 v10, s[40:43], s55 offen offset:1024 sc1 lds
    buffer_load_dwordx4 v10, s[40:43], s55 offen offset:2048 sc1 lds
    buffer_load_dwordx4 v10, s[40:43], s55 offen offset:3072 sc1 lds
    s_add_u32 m0, s57, 36864
    s_add_u32 s55, s56, 4096
    buffer_load_dwordx4 v10, s[40:43], s55 offen offset:0 sc1 lds
    buffer_load_dwordx4 v10, s[40:43], s55 offen offset:1024 sc1 lds
    buffer_load_dwordx4 v10, s[40:43], s55 offen offset:2048 sc1 lds
    buffer_load_dwordx4 v10, s[40:43], s55 offen offset:3072 sc1 lds
    s_add_u32 m0, s57, 40960
    s_add_u32 s55, s56, 8192
    buffer_load_dwordx4 v10, s[40:43], s55 offen offset:0 sc1 lds
    buffer_load_dwordx4 v10, s[40:43], s55 offen offset:1024 sc1 lds
    buffer_load_dwordx4 v10, s[40:43], s55 offen offset:2048 sc1 lds
    buffer_load_dwordx4 v10, s[40:43], s55 offen offset:3072 sc1 lds
    s_cmp_lg_u32 s52, 1
    s_cbranch_scc1 L_nohf_82
    s_waitcnt vmcnt(24)
    v_mov_b32 v12, s44
    v_mov_b32 v13, 0
    s_mov_b64 exec, 1
    buffer_store_dword v12, v13, s[40:43], s59 offen sc1
    s_mov_b64 exec, -1
L_nohf_82:
    s_waitcnt vmcnt(12)
    v_mov_b32 v12, s44
    v_mov_b32 v13, s62
    s_mov_b64 exec, 1
    ds_write_b32 v13, v12 offset:0
    s_mov_b64 exec, -1
    s_waitcnt vmcnt(0)
    s_mov_b32 s55, s63
    s_mov_b32 s57, s53
    v_mov_b32 v12, s44
    v_mov_b32 v13, s62
    s_mov_b64 exec, 1
    ds_write_b32 v13, v12 offset:16
    s_mov_b64 exec, -1
    s_cmp_lg_u32 s52, 0
    s_cbranch_scc1 L_hl1_86
    s_cmp_eq_u32 s54, 0
    s_cbranch_scc1 L_hz_84
    s_sub_u32 s59, s59, 2048
    s_sub_u32 s58, s58, 65536
    v_mov_b32 v7, 0
    s_mov_b32 s50, 30000
L_pl_87:
    buffer_load_dword v6, v7, s[40:43], s59 offen sc1
    s_waitcnt vmcnt(0)
    v_cmp_ne_u32 vcc, s44, v6
    s_nop 1
    s_cmp_eq_u64 vcc, 0
    s_cbranch_scc1 L_pld_88
    s_sleep 8
    s_sub_u32 s50, s50, 1
    s_cmp_lg_u32 s50, 0
    s_cbranch_scc1 L_pl_87
L_pld_88:
    buffer_load_dwordx4 v[88:91], v139, s[40:43], s58 offen offset:0 sc1
    buffer_load_dwordx4 v[92:95], v139, s[40:43], s58 offen offset:1024 sc1
    buffer_load_dwordx4 v[96:99], v139, s[40:43], s58 offen offset:2048 sc1
    s_waitcnt vmcnt(0)
    s_branch L_nohl_85
L_hz_84:
    v_mov_b32 v88, 0
    v_mov_b32 v89, 0
    v_mov_b32 v90, 0
    v_mov_b32 v91, 0
    v_mov_b32 v92, 0
    v_mov_b32 v93, 0
    v_mov_b32 v94, 0
    v_mov_b32 v95, 0
    v_mov_b32 v96, 0
    v_mov_b32 v97, 0
    v_mov_b32 v98, 0
    v_mov_b32 v99, 0
    s_branch L_nohl_85
L_hl1_86:
    v_mov_b32 v7, s60
    v_add_u32 v4, s57, v139
    s_mov_b32 s50, 0x80000
L_lw_89:
    ds_read_b32 v6, v7 offset:0
    s_waitcnt lgkmcnt(0)
    v_cmp_ne_u32 vcc, s44, v6
    s_nop 1
    s_cmp_eq_u64 vcc, 0
    s_cbranch_scc1 L_lwd_90
    s_sleep 1
    s_sub_u32 s50, s50, 1
    s_cmp_lg_u32 s50, 0
    s_cbranch_scc1 L_lw_89
L_lwd_90:
    ds_read_b128 v[88:91], v4 offset:0
    ds_read_b128 v[92:95], v4 offset:1024
    ds_read_b128 v[96:99], v4 offset:2048
    s_waitcnt lgkmcnt(0)
L_nohl_85:
    s_nop 1
    v_mfma_f32_32x32x16_bf16 v[16:31], v[72:75], v[64:67], 0
    v_mfma_f32_32x32x16_bf16 v[32:47], v[88:91], v[64:67], 0
    s_nop 10
    ds_write_b128 v136, v[16:19] offset:64
    ds_write_b128 v136, v[20:23] offset:96
    ds_write_b128 v136, v[24:27] offset:128
    ds_write_b128 v136, v[28:31] offset:160
    ds_write_b128 v136, v[40:43] offset:0
    ds_write_b128 v136, v[44:47] offset:32
    s_mov_b32 exec_hi, 0
    ds_read2_b32 v[100:101], v137 offset0:0 offset1:2
    ds_read2_b32 v[102:103], v137 offset0:4 offset1:6
    ds_read2_b32 v[104:105], v137 offset0:8 offset1:10
    ds_read2_b32 v[106:107], v137 offset0:12 offset1:14
    s_mov_b64 exec, -1
    s_waitcnt lgkmcnt(4)
    v_mfma_f32_32x32x16_bf16 v[16:31], v[76:79], v[68:71], 0
    v_mfma_f32_32x32x16_bf16 v[32:47], v[92:95], v[68:71], 0
    s_nop 10
    ds_write_b128 v136, v[16:19] offset:64
    ds_write_b128 v136, v[20:23] offset:96
    ds_write_b128 v136, v[24:27] offset:128
    ds_write_b128 v136, v[28:31] offset:160
    ds_write_b128 v136, v[40:43] offset:0
    ds_write_b128 v136, v[44:47] offset:32
    s_mov_b32 exec_lo, 0
    ds_read2_b32 v[100:101], v137 offset0:0 offset1:2
    ds_read2_b32 v[102:103], v137 offset0:4 offset1:6
    ds_read2_b32 v[104:105], v137 offset0:8 offset1:10
    ds_read2_b32 v[106:107], v137 offset0:12 offset1:14
    s_mov_b64 exec, -1
    v_mov_b32 v108, 0
    v_mov_b32 v109, 0
    v_mov_b32 v110, 0
    v_mov_b32 v111, 0
    v_add_u32 v4, s57, v139
    ds_write_b128 v4, v[108:111] offset:0
    ds_write_b128 v4, v[108:111] offset:1024
    ds_write_b128 v4, v[108:111] offset:2048
    ds_write_b128 v4, v[108:111] offset:3072
    ds_write_b128 v4, v[108:111] offset:4096
    ds_write_b128 v4, v[108:111] offset:5120
    ds_write_b128 v4, v[108:111] offset:6144
    s_waitcnt lgkmcnt(7)
    v_cvt_pk_bf16_f32 v120, v100, v101
    v_cvt_pk_bf16_f32 v121, v102, v103
    v_cvt_pk_bf16_f32 v122, v104, v105
    v_cvt_pk_bf16_f32 v123, v106, v107
    v_lshlrev_b32 v100, 16, v120
    v_and_b32 v101, 0xffff0000, v120
    v_lshlrev_b32 v102, 16, v121
    v_and_b32 v103, 0xffff0000, v121
    v_lshlrev_b32 v104, 16, v122
    v_and_b32 v105, 0xffff0000, v122
    v_lshlrev_b32 v106, 16, v123
    v_and_b32 v107, 0xffff0000, v123
    s_cmp_lg_u32 s54, 0
    s_cbranch_scc1 L_nomask_91
    v_mov_b32 v6, 0xf149f2ca
    v_and_b32 v2, 31, v1
    v_cmp_gt_u32 vcc, 2, v2
    s_nop 1
    v_cndmask_b32 v106, v106, v6, vcc
    v_cmp_gt_u32 vcc, 4, v2
    s_nop 1
    v_cndmask_b32 v105, v105, v6, vcc
    v_cmp_gt_u32 vcc, 6, v2
    s_nop 1
    v_cndmask_b32 v104, v104, v6, vcc
    v_cmp_gt_u32 vcc, 8, v2
    s_nop 1
    v_cndmask_b32 v103, v103, v6, vcc
    v_cmp_gt_u32 vcc, 10, v2
    s_nop 1
    v_cndmask_b32 v102, v102, v6, vcc
    v_cmp_gt_u32 vcc, 12, v2
    s_nop 1
    v_cndmask_b32 v101, v101, v6, vcc
    v_cmp_gt_u32 vcc, 14, v2
    s_nop 1
    v_cndmask_b32 v100, v100, v6, vcc
L_nomask_91:
    v_max3_f32 v6, v100, v101, v102
    v_max3_f32 v7, v103, v104, v105
    v_max3_f32 v6, v6, v106, v107
    v_max_f32 v6, v6, v7
    s_mov_b32 s60, 1052289595
    v_sub_f32 v100, v100, v6
    v_sub_f32 v101, v101, v6
    v_sub_f32 v102, v102, v6
    v_sub_f32 v103, v103, v6
    v_sub_f32 v104, v104, v6
    v_sub_f32 v105, v105, v6
    v_sub_f32 v106, v106, v6
    v_sub_f32 v107, v107, v6
    v_mul_f32 v100, s60, v100
    v_mul_f32 v101, s60, v101
    v_mul_f32 v102, s60, v102
    v_mul_f32 v103, s60, v103
    v_mul_f32 v104, s60, v104
    v_mul_f32 v105, s60, v105
    v_mul_f32 v106, s60, v106
    v_mul_f32 v107, s60, v107
    v_exp_f32 v100, v100
    v_exp_f32 v101, v101
    v_exp_f32 v102, v102
    v_exp_f32 v103, v103
    v_exp_f32 v104, v104
    v_exp_f32 v105, v105
    v_exp_f32 v106, v106
    v_exp_f32 v107, v107
    v_add_f32 v6, v100, v101
    v_add_f32 v7, v102, v103
    v_add_f32 v8, v104, v105
    v_add_f32 v9, v106, v107
    v_add_f32 v6, v6, v7
    v_add_f32 v8, v8, v9
    v_add_f32 v6, v6, v8
    v_rcp_f32 v6, v6
    s_nop 0
    v_mul_f32 v100, v100, v6
    v_mul_f32 v101, v101, v6
    v_mul_f32 v102, v102, v6
    v_mul_f32 v103, v103, v6
    v_mul_f32 v104, v104, v6
    v_mul_f32 v105, v105, v6
    v_mul_f32 v106, v106, v6
    v_mul_f32 v107, v107, v6
    v_cvt_pk_bf16_f32 v120, v100, v101
    v_cvt_pk_bf16_f32 v121, v102, v103
    v_cvt_pk_bf16_f32 v122, v104, v105
    v_cvt_pk_bf16_f32 v123, v106, v107
    ds_write_b16 v128, v120
    ds_write_b16_d16_hi v129, v120
    ds_write_b16 v130, v121
    ds_write_b16_d16_hi v131, v121
    ds_write_b16 v132, v122
    ds_write_b16_d16_hi v133, v122
    ds_write_b16 v134, v123
    ds_write_b16_d16_hi v135, v123
    ds_read_b128 v[108:111], v138 offset:0
    ds_read_b128 v[112:115], v138 offset:32
    ds_read_b128 v[116:119], v138 offset:64
    ds_read_b128 v[48:51], v138 offset:3584
    ds_read_b128 v[52:55], v138 offset:3616
    ds_read_b128 v[56:59], v138 offset:3648
    s_lshl_b32 s58, s54, 15
    s_lshl_b32 s59, s55, 11
    s_add_u32 s58, s58, s59
    s_add_u32 s58, s58, 8388608
    s_lshl_b32 s59, s54, 11
    s_lshl_b32 s60, s55, 7
    s_add_u32 s59, s59, s60
    s_add_u32 s59, s59, 12976128
    s_lshl_b32 s60, s51, 2
    s_add_u32 s60, s60, 30816
    s_waitcnt lgkmcnt(3)
    v_mfma_f32_32x32x16_bf16 v[16:31], v[96:99], v[108:111], 0
    v_mfma_f32_32x32x16_bf16 v[16:31], v[80:83], v[112:115], v[16:31]
    v_mfma_f32_32x32x16_bf16 v[16:31], v[84:87], v[116:119], v[16:31]
    s_waitcnt lgkmcnt(0)
    v_mfma_f32_32x32x16_bf16 v[32:47], v[96:99], v[48:51], 0
    v_mfma_f32_32x32x16_bf16 v[32:47], v[80:83], v[52:55], v[32:47]
    v_mfma_f32_32x32x16_bf16 v[32:47], v[84:87], v[56:59], v[32:47]
    v_mov_b32 v6, s44
    v_mov_b32 v7, s60
    s_mov_b64 exec, 1
    ds_write_b32 v7, v6 offset:0
    s_mov_b64 exec, -1
    s_nop 3
    v_cvt_pk_bf16_f32 v64, v16, v17
    v_cvt_pk_bf16_f32 v65, v18, v19
    v_cvt_pk_bf16_f32 v66, v20, v21
    v_cvt_pk_bf16_f32 v67, v22, v23
    buffer_store_dwordx4 v[64:67], v139, s[40:43], s58 offen sc1
    v_cvt_pk_bf16_f32 v68, v40, v41
    v_cvt_pk_bf16_f32 v69, v42, v43
    v_cvt_pk_bf16_f32 v70, v44, v45
    v_cvt_pk_bf16_f32 v71, v46, v47
    buffer_store_dwordx4 v[68:71], v139, s[40:43], s58 offen offset:1024 sc1
    s_waitcnt vmcnt(0)
    v_mov_b32 v6, s44
    v_mov_b32 v7, 0
    s_mov_b64 exec, 1
    buffer_store_dword v6, v7, s[40:43], s59 offen sc1
    s_mov_b64 exec, -1
    s_mov_b32 s50, 0x80000
L_lw_92:
    ds_read_b32 v12, v11 offset:96
    s_waitcnt lgkmcnt(0)
    v_cmp_ne_u32 vcc, s44, v12
    s_nop 1
    s_cmp_eq_u64 vcc, 0
    s_cbranch_scc1 L_lwd_93
    s_sleep 1
    s_sub_u32 s50, s50, 1
    s_cmp_lg_u32 s50, 0
    s_cbranch_scc1 L_lw_92
L_lwd_93:
    s_lshl_b32 s61, s4, 3
    s_and_b32 s50, s5, 7
    s_add_u32 s61, s61, s50
    s_lshr_b32 s62, s5, 3
    s_lshl_b32 s62, s62, 8
    s_lshl_b32 s50, s51, 6
    s_add_u32 s62, s62, s50
    s_mul_i32 s63, s51, 7680
    v_lshrrev_b32 v14, 2, v1
    v_lshlrev_b32 v14, 10, v14
    v_and_b32 v15, 3, v1
    v_lshlrev_b32 v15, 4, v15
    v_add_u32 v14, v14, v15
    v_lshrrev_b32 v15, 5, v1
    v_lshlrev_b32 v15, 8, v15
    v_and_b32 v2, 12, v1
    v_lshlrev_b32 v2, 4, v2
    v_add_u32 v15, v15, v2
    v_and_b32 v2, 16, v1
    v_lshlrev_b32 v2, 1, v2
    v_add_u32 v15, v15, v2
    v_and_b32 v2, 3, v1
    v_lshlrev_b32 v2, 3, v2
    v_add_u32 v15, v15, v2
    v_add_u32 v15, s63, v15
    s_add_u32 m0, s63, 0
    s_add_u32 s50, s62, 0
    buffer_load_dwordx4 v14, s[16:19], s50 offen lds
    s_add_u32 m0, s63, 1024
    s_add_u32 s50, s62, 16384
    buffer_load_dwordx4 v14, s[16:19], s50 offen lds
    s_add_u32 m0, s63, 2048
    s_add_u32 s50, s62, 32768
    buffer_load_dwordx4 v14, s[16:19], s50 offen lds
    s_add_u32 m0, s63, 3072
    s_add_u32 s50, s62, 49152
    buffer_load_dwordx4 v14, s[16:19], s50 offen lds
    s_add_u32 m0, s63, 4096
    s_add_u32 s50, s62, 65536
    buffer_load_dwordx4 v14, s[16:19], s50 offen lds
    s_add_u32 m0, s63, 5120
    s_add_u32 s50, s62, 81920
    buffer_load_dwordx4 v14, s[16:19], s50 offen lds
    s_add_u32 m0, s63, 6144
    s_add_u32 s50, s62, 98304
    buffer_load_dwordx4 v14, s[16:19], s50 offen lds
    s_waitcnt vmcnt(6)
    ds_read_b64_tr_b16 v[40:41], v15 offset:0
    ds_read_b64_tr_b16 v[42:43], v15 offset:512
    s_waitcnt vmcnt(5)
    ds_read_b64_tr_b16 v[44:45], v15 offset:1024
    ds_read_b64_tr_b16 v[46:47], v15 offset:1536
    s_waitcnt lgkmcnt(2)
    s_add_u32 m0, s63, 0
    s_add_u32 s50, s62, 114688
    buffer_load_dwordx4 v14, s[16:19], s50 offen lds
    s_waitcnt vmcnt(5)
    ds_read_b64_tr_b16 v[48:49], v15 offset:2048
    ds_read_b64_tr_b16 v[50:51], v15 offset:2560
    s_waitcnt lgkmcnt(2)
    s_add_u32 m0, s63, 1024
    s_add_u32 s50, s62, 131072
    buffer_load_dwordx4 v14, s[16:19], s50 offen lds
    s_waitcnt vmcnt(5)
    ds_read_b64_tr_b16 v[52:53], v15 offset:3072
    ds_read_b64_tr_b16 v[54:55], v15 offset:3584
    s_waitcnt lgkmcnt(2)
    s_add_u32 m0, s63, 2048
    s_add_u32 s50, s62, 147456
    buffer_load_dwordx4 v14, s[16:19], s50 offen lds
    s_waitcnt vmcnt(5)
    ds_read_b64_tr_b16 v[56:57], v15 offset:4096
    ds_read_b64_tr_b16 v[58:59], v15 offset:4608
    s_waitcnt lgkmcnt(2)
    s_add_u32 m0, s63, 3072
    s_add_u32 s50, s62, 163840
    buffer_load_dwordx4 v14, s[16:19], s50 offen lds
    s_waitcnt vmcnt(5)
    ds_read_b64_tr_b16 v[60:61], v15 offset:5120
    ds_read_b64_tr_b16 v[62:63], v15 offset:5632
    s_waitcnt lgkmcnt(2)
    s_add_u32 m0, s63, 4096
    s_add_u32 s50, s62, 180224
    buffer_load_dwordx4 v14, s[16:19], s50 offen lds
    s_waitcnt vmcnt(5)
    ds_read_b64_tr_b16 v[64:65], v15 offset:6144
    ds_read_b64_tr_b16 v[66:67], v15 offset:6656
    s_waitcnt lgkmcnt(2)
    s_add_u32 m0, s63, 5120
    s_add_u32 s50, s62, 196608
    buffer_load_dwordx4 v14, s[16:19], s50 offen lds
    s_waitcnt vmcnt(5)
    ds_read_b64_tr_b16 v[68:69], v15 offset:0
    ds_read_b64_tr_b16 v[70:71], v15 offset:512
    s_waitcnt lgkmcnt(2)
    s_add_u32 m0, s63, 6144
    s_add_u32 s50, s62, 212992
    buffer_load_dwordx4 v14, s[16:19], s50 offen lds
    s_waitcnt vmcnt(5)
    ds_read_b64_tr_b16 v[72:73], v15 offset:1024
    ds_read_b64_tr_b16 v[74:75], v15 offset:1536
    s_waitcnt lgkmcnt(2)
    s_add_u32 m0, s63, 0
    s_add_u32 s50, s62, 229376
    buffer_load_dwordx4 v14, s[16:19], s50 offen lds
    s_waitcnt vmcnt(5)
    ds_read_b64_tr_b16 v[76:77], v15 offset:2048
    ds_read_b64_tr_b16 v[78:79], v15 offset:2560
    s_waitcnt lgkmcnt(2)
    s_add_u32 m0, s63, 1024
    s_add_u32 s50, s62, 245760
    buffer_load_dwordx4 v14, s[16:19], s50 offen lds
    s_waitcnt vmcnt(5)
    ds_read_b64_tr_b16 v[80:81], v15 offset:3072
    ds_read_b64_tr_b16 v[82:83], v15 offset:3584
    s_waitcnt lgkmcnt(2)
    s_add_u32 m0, s63, 2048
    s_add_u32 s50, s62, 262144
    buffer_load_dwordx4 v14, s[16:19], s50 offen lds
    s_waitcnt vmcnt(5)
    ds_read_b64_tr_b16 v[84:85], v15 offset:4096
    ds_read_b64_tr_b16 v[86:87], v15 offset:4608
    s_waitcnt lgkmcnt(2)
    s_add_u32 m0, s63, 3072
    s_add_u32 s50, s62, 278528
    buffer_load_dwordx4 v14, s[16:19], s50 offen lds
    s_waitcnt vmcnt(5)
    ds_read_b64_tr_b16 v[88:89], v15 offset:5120
    ds_read_b64_tr_b16 v[90:91], v15 offset:5632
    s_waitcnt lgkmcnt(2)
    s_add_u32 m0, s63, 4096
    s_add_u32 s50, s62, 294912
    buffer_load_dwordx4 v14, s[16:19], s50 offen lds
    s_waitcnt vmcnt(5)
    ds_read_b64_tr_b16 v[92:93], v15 offset:6144
    ds_read_b64_tr_b16 v[94:95], v15 offset:6656
    s_waitcnt lgkmcnt(2)
    s_add_u32 m0, s63, 5120
    s_add_u32 s50, s62, 311296
    buffer_load_dwordx4 v14, s[16:19], s50 offen lds
    s_waitcnt vmcnt(5)
    ds_read_b64_tr_b16 v[96:97], v15 offset:0
    ds_read_b64_tr_b16 v[98:99], v15 offset:512
    s_waitcnt lgkmcnt(2)
    s_add_u32 m0, s63, 6144
    s_add_u32 s50, s62, 327680
    buffer_load_dwordx4 v14, s[16:19], s50 offen lds
    s_waitcnt vmcnt(5)
    ds_read_b64_tr_b16 v[100:101], v15 offset:1024
    ds_read_b64_tr_b16 v[102:103], v15 offset:1536
    s_waitcnt lgkmcnt(2)
    s_add_u32 m0, s63, 0
    s_add_u32 s50, s62, 344064
    buffer_load_dwordx4 v14, s[16:19], s50 offen lds
    s_waitcnt vmcnt(5)
    ds_read_b64_tr_b16 v[104:105], v15 offset:2048
    ds_read_b64_tr_b16 v[106:107], v15 offset:2560
    s_waitcnt lgkmcnt(2)
    s_add_u32 m0, s63, 1024
    s_add_u32 s50, s62, 360448
    buffer_load_dwordx4 v14, s[16:19], s50 offen lds
    s_waitcnt vmcnt(5)
    ds_read_b64_tr_b16 v[108:109], v15 offset:3072
    ds_read_b64_tr_b16 v[110:111], v15 offset:3584
    s_waitcnt lgkmcnt(2)
    s_add_u32 m0, s63, 2048
    s_add_u32 s50, s62, 376832
    buffer_load_dwordx4 v14, s[16:19], s50 offen lds
    s_waitcnt vmcnt(5)
    ds_read_b64_tr_b16 v[112:113], v15 offset:4096
    ds_read_b64_tr_b16 v[114:115], v15 offset:4608
    s_waitcnt lgkmcnt(2)
    s_add_u32 m0, s63, 3072
    s_add_u32 s50, s62, 393216
    buffer_load_dwordx4 v14, s[16:19], s50 offen lds
    s_waitcnt vmcnt(5)
    ds_read_b64_tr_b16 v[116:117], v15 offset:5120
    ds_read_b64_tr_b16 v[118:119], v15 offset:5632
    s_waitcnt lgkmcnt(2)
    s_add_u32 m0, s63, 4096
    s_add_u32 s50, s62, 409600
    buffer_load_dwordx4 v14, s[16:19], s50 offen lds
    s_waitcnt vmcnt(5)
    ds_read_b64_tr_b16 v[120:121], v15 offset:6144
    ds_read_b64_tr_b16 v[122:123], v15 offset:6656
    s_waitcnt lgkmcnt(2)
    s_add_u32 m0, s63, 5120
    s_add_u32 s50, s62, 425984
    buffer_load_dwordx4 v14, s[16:19], s50 offen lds
    s_waitcnt vmcnt(5)
    ds_read_b64_tr_b16 v[124:125], v15 offset:0
    ds_read_b64_tr_b16 v[126:127], v15 offset:512
    s_waitcnt lgkmcnt(2)
    s_add_u32 m0, s63, 6144
    s_add_u32 s50, s62, 442368
    buffer_load_dwordx4 v14, s[16:19], s50 offen lds
    s_waitcnt vmcnt(5)
    ds_read_b64_tr_b16 v[128:129], v15 offset:1024
    ds_read_b64_tr_b16 v[130:131], v15 offset:1536
    s_waitcnt lgkmcnt(2)
    s_add_u32 m0, s63, 0
    s_add_u32 s50, s62, 458752
    buffer_load_dwordx4 v14, s[16:19], s50 offen lds
    s_waitcnt vmcnt(5)
    ds_read_b64_tr_b16 v[132:133], v15 offset:2048
    ds_read_b64_tr_b16 v[134:135], v15 offset:2560
    s_waitcnt lgkmcnt(2)
    s_add_u32 m0, s63, 1024
    s_add_u32 s50, s62, 475136
    buffer_load_dwordx4 v14, s[16:19], s50 offen lds
    s_waitcnt vmcnt(5)
    ds_read_b64_tr_b16 v[136:137], v15 offset:3072
    ds_read_b64_tr_b16 v[138:139], v15 offset:3584
    s_waitcnt lgkmcnt(2)
    s_add_u32 m0, s63, 2048
    s_add_u32 s50, s62, 491520
    buffer_load_dwordx4 v14, s[16:19], s50 offen lds
    s_waitcnt vmcnt(5)
    ds_read_b64_tr_b16 v[140:141], v15 offset:4096
    ds_read_b64_tr_b16 v[142:143], v15 offset:4608
    s_waitcnt lgkmcnt(2)
    s_add_u32 m0, s63, 3072
    s_add_u32 s50, s62, 507904
    buffer_load_dwordx4 v14, s[16:19], s50 offen lds
    s_waitcnt vmcnt(5)
    ds_read_b64_tr_b16 v[144:145], v15 offset:5120
    ds_read_b64_tr_b16 v[146:147], v15 offset:5632
    s_waitcnt vmcnt(4)
    ds_read_b64_tr_b16 v[148:149], v15 offset:6144
    ds_read_b64_tr_b16 v[150:151], v15 offset:6656
    s_waitcnt vmcnt(3)
    ds_read_b64_tr_b16 v[152:153], v15 offset:0
    ds_read_b64_tr_b16 v[154:155], v15 offset:512
    s_waitcnt vmcnt(2)
    ds_read_b64_tr_b16 v[156:157], v15 offset:1024
    ds_read_b64_tr_b16 v[158:159], v15 offset:1536
    s_waitcnt vmcnt(1)
    ds_read_b64_tr_b16 v[160:161], v15 offset:2048
    ds_read_b64_tr_b16 v[162:163], v15 offset:2560
    s_waitcnt vmcnt(0)
    ds_read_b64_tr_b16 v[164:165], v15 offset:3072
    ds_read_b64_tr_b16 v[166:167], v15 offset:3584
    s_waitcnt lgkmcnt(0)
    v_and_b32 v2, 15, v1
    v_lshlrev_b32 v2, 7, v2
    s_lshl_b32 s56, s61, 11
    s_add_u32 s56, s56, 12976128
    s_mov_b32 s50, 30000
L_pl_94:
    buffer_load_dword v3, v2, s[40:43], s56 offen sc1
    s_waitcnt vmcnt(0)
    v_cmp_ne_u32 vcc, s44, v3
    s_nop 1
    s_cmp_eq_u64 vcc, 0
    s_cbranch_scc1 L_pld_95
    s_sleep 16
    s_sub_u32 s50, s50, 1
    s_cmp_lg_u32 s50, 0
    s_cbranch_scc1 L_pl_94
L_pld_95:
    v_lshlrev_b32 v0, 4, v1
    s_lshl_b32 s56, s61, 15
    s_add_u32 s56, s56, 8388608
    s_add_u32 s57, s56, 0
    buffer_load_dwordx4 v[2:5], v0, s[40:43], s57 offen offset:0 sc1
    s_add_u32 s57, s56, 0
    buffer_load_dwordx4 v[6:9], v0, s[40:43], s57 offen offset:1024 sc1
    s_add_u32 s57, s56, 0
    buffer_load_dwordx4 v[10:13], v0, s[40:43], s57 offen offset:2048 sc1
    s_add_u32 s57, s56, 0
    buffer_load_dwordx4 v[32:35], v0, s[40:43], s57 offen offset:3072 sc1
    s_add_u32 s57, s56, 4096
    buffer_load_dwordx4 v[36:39], v0, s[40:43], s57 offen offset:0 sc1
    s_waitcnt vmcnt(4)
    v_mfma_f32_32x32x16_bf16 v[16:31], v[40:43], v[2:5], 0
    s_add_u32 s57, s56, 4096
    buffer_load_dwordx4 v[2:5], v0, s[40:43], s57 offen offset:1024 sc1
    s_waitcnt vmcnt(4)
    v_mfma_f32_32x32x16_bf16 v[16:31], v[44:47], v[6:9], v[16:31]
    s_add_u32 s57, s56, 4096
    buffer_load_dwordx4 v[6:9], v0, s[40:43], s57 offen offset:2048 sc1
    s_waitcnt vmcnt(4)
    v_mfma_f32_32x32x16_bf16 v[16:31], v[48:51], v[10:13], v[16:31]
    s_add_u32 s57, s56, 4096
    buffer_load_dwordx4 v[10:13], v0, s[40:43], s57 offen offset:3072 sc1
    s_waitcnt vmcnt(4)
    v_mfma_f32_32x32x16_bf16 v[16:31], v[52:55], v[32:35], v[16:31]
    s_add_u32 s57, s56, 8192
    buffer_load_dwordx4 v[32:35], v0, s[40:43], s57 offen offset:0 sc1
    s_waitcnt vmcnt(4)
    v_mfma_f32_32x32x16_bf16 v[16:31], v[56:59], v[36:39], v[16:31]
    s_add_u32 s57, s56, 8192
    buffer_load_dwordx4 v[36:39], v0, s[40:43], s57 offen offset:1024 sc1
    s_waitcnt vmcnt(4)
    v_mfma_f32_32x32x16_bf16 v[16:31], v[60:63], v[2:5], v[16:31]
    s_add_u32 s57, s56, 8192
    buffer_load_dwordx4 v[2:5], v0, s[40:43], s57 offen offset:2048 sc1
    s_waitcnt vmcnt(4)
    v_mfma_f32_32x32x16_bf16 v[16:31], v[64:67], v[6:9], v[16:31]
    s_add_u32 s57, s56, 8192
    buffer_load_dwordx4 v[6:9], v0, s[40:43], s57 offen offset:3072 sc1
    s_waitcnt vmcnt(4)
    v_mfma_f32_32x32x16_bf16 v[16:31], v[68:71], v[10:13], v[16:31]
    s_add_u32 s57, s56, 12288
    buffer_load_dwordx4 v[10:13], v0, s[40:43], s57 offen offset:0 sc1
    s_waitcnt vmcnt(4)
    v_mfma_f32_32x32x16_bf16 v[16:31], v[72:75], v[32:35], v[16:31]
    s_add_u32 s57, s56, 12288
    buffer_load_dwordx4 v[32:35], v0, s[40:43], s57 offen offset:1024 sc1
    s_waitcnt vmcnt(4)
    v_mfma_f32_32x32x16_bf16 v[16:31], v[76:79], v[36:39], v[16:31]
    s_add_u32 s57, s56, 12288
    buffer_load_dwordx4 v[36:39], v0, s[40:43], s57 offen offset:2048 sc1
    s_waitcnt vmcnt(4)
    v_mfma_f32_32x32x16_bf16 v[16:31], v[80:83], v[2:5], v[16:31]
    s_add_u32 s57, s56, 12288
    buffer_load_dwordx4 v[2:5], v0, s[40:43], s57 offen offset:3072 sc1
    s_waitcnt vmcnt(4)
    v_mfma_f32_32x32x16_bf16 v[16:31], v[84:87], v[6:9], v[16:31]
    s_add_u32 s57, s56, 16384
    buffer_load_dwordx4 v[6:9], v0, s[40:43], s57 offen offset:0 sc1
    s_waitcnt vmcnt(4)
    v_mfma_f32_32x32x16_bf16 v[16:31], v[88:91], v[10:13], v[16:31]
    s_add_u32 s57, s56, 16384
    buffer_load_dwordx4 v[10:13], v0, s[40:43], s57 offen offset:1024 sc1
    s_waitcnt vmcnt(4)
    v_mfma_f32_32x32x16_bf16 v[16:31], v[92:95], v[32:35], v[16:31]
    s_add_u32 s57, s56, 16384
    buffer_load_dwordx4 v[32:35], v0, s[40:43], s57 offen offset:2048 sc1
    s_waitcnt vmcnt(4)
    v_mfma_f32_32x32x16_bf16 v[16:31], v[96:99], v[36:39], v[16:31]
    s_add_u32 s57, s56, 16384
    buffer_load_dwordx4 v[36:39], v0, s[40:43], s57 offen offset:3072 sc1
    s_waitcnt vmcnt(4)
    v_mfma_f32_32x32x16_bf16 v[16:31], v[100:103], v[2:5], v[16:31]
    s_add_u32 s57, s56, 20480
    buffer_load_dwordx4 v[2:5], v0, s[40:43], s57 offen offset:0 sc1
    s_waitcnt vmcnt(4)
    v_mfma_f32_32x32x16_bf16 v[16:31], v[104:107], v[6:9], v[16:31]
    s_add_u32 s57, s56, 20480
    buffer_load_dwordx4 v[6:9], v0, s[40:43], s57 offen offset:1024 sc1
    s_waitcnt vmcnt(4)
    v_mfma_f32_32x32x16_bf16 v[16:31], v[108:111], v[10:13], v[16:31]
    s_add_u32 s57, s56, 20480
    buffer_load_dwordx4 v[10:13], v0, s[40:43], s57 offen offset:2048 sc1
    s_waitcnt vmcnt(4)
    v_mfma_f32_32x32x16_bf16 v[16:31], v[112:115], v[32:35], v[16:31]
    s_add_u32 s57, s56, 20480
    buffer_load_dwordx4 v[32:35], v0, s[40:43], s57 offen offset:3072 sc1
    s_waitcnt vmcnt(4)
    v_mfma_f32_32x32x16_bf16 v[16:31], v[116:119], v[36:39], v[16:31]
    s_add_u32 s57, s56, 24576
    buffer_load_dwordx4 v[36:39], v0, s[40:43], s57 offen offset:0 sc1
    s_waitcnt vmcnt(4)
    v_mfma_f32_32x32x16_bf16 v[16:31], v[120:123], v[2:5], v[16:31]
    s_add_u32 s57, s56, 24576
    buffer_load_dwordx4 v[2:5], v0, s[40:43], s57 offen offset:1024 sc1
    s_waitcnt vmcnt(4)
    v_mfma_f32_32x32x16_bf16 v[16:31], v[124:127], v[6:9], v[16:31]
    s_add_u32 s57, s56, 24576
    buffer_load_dwordx4 v[6:9], v0, s[40:43], s57 offen offset:2048 sc1
    s_waitcnt vmcnt(4)
    v_mfma_f32_32x32x16_bf16 v[16:31], v[128:131], v[10:13], v[16:31]
    s_add_u32 s57, s56, 24576
    buffer_load_dwordx4 v[10:13], v0, s[40:43], s57 offen offset:3072 sc1
    s_waitcnt vmcnt(4)
    v_mfma_f32_32x32x16_bf16 v[16:31], v[132:135], v[32:35], v[16:31]
    s_add_u32 s57, s56, 28672
    buffer_load_dwordx4 v[32:35], v0, s[40:43], s57 offen offset:0 sc1
    s_waitcnt vmcnt(4)
    v_mfma_f32_32x32x16_bf16 v[16:31], v[136:139], v[36:39], v[16:31]
    s_add_u32 s57, s56, 28672
    buffer_load_dwordx4 v[36:39], v0, s[40:43], s57 offen offset:1024 sc1
    s_waitcnt vmcnt(4)
    v_mfma_f32_32x32x16_bf16 v[16:31], v[140:143], v[2:5], v[16:31]
    s_add_u32 s57, s56, 28672
    buffer_load_dwordx4 v[2:5], v0, s[40:43], s57 offen offset:2048 sc1
    s_waitcnt vmcnt(4)
    v_mfma_f32_32x32x16_bf16 v[16:31], v[144:147], v[6:9], v[16:31]
    s_add_u32 s57, s56, 28672
    buffer_load_dwordx4 v[6:9], v0, s[40:43], s57 offen offset:3072 sc1
    s_waitcnt vmcnt(4)
    v_mfma_f32_32x32x16_bf16 v[16:31], v[148:151], v[10:13], v[16:31]
    s_waitcnt vmcnt(3)
    v_mfma_f32_32x32x16_bf16 v[16:31], v[152:155], v[32:35], v[16:31]
    s_waitcnt vmcnt(2)
    v_mfma_f32_32x32x16_bf16 v[16:31], v[156:159], v[36:39], v[16:31]
    s_waitcnt vmcnt(1)
    v_mfma_f32_32x32x16_bf16 v[16:31], v[160:163], v[2:5], v[16:31]
    s_waitcnt vmcnt(0)
    v_mfma_f32_32x32x16_bf16 v[16:31], v[164:167], v[6:9], v[16:31]
    v_and_b32 v2, 31, v1
    v_lshlrev_b32 v2, 11, v2
    v_lshrrev_b32 v3, 5, v1
    v_lshlrev_b32 v3, 4, v3
    v_add_u32 v2, v2, v3
    s_lshl_b32 s55, s61, 16
    s_add_u32 s55, s55, s62
    s_add_u32 s55, s55, 0
    s_nop 11
    v_cvt_pk_bf16_f32 v32, v16, v17
    v_cvt_pk_bf16_f32 v33, v18, v19
    v_cvt_pk_bf16_f32 v34, v20, v21
    v_cvt_pk_bf16_f32 v35, v22, v23
    v_cvt_pk_bf16_f32 v36, v24, v25
    v_cvt_pk_bf16_f32 v37, v26, v27
    v_cvt_pk_bf16_f32 v38, v28, v29
    v_cvt_pk_bf16_f32 v39, v30, v31
    s_nop 1
    v_permlane32_swap_b32 v32, v34
    v_permlane32_swap_b32 v33, v35
    v_permlane32_swap_b32 v36, v38
    v_permlane32_swap_b32 v37, v39
    buffer_store_dwordx4 v[32:35], v2, s[32:35], s55 offen sc1
    buffer_store_dwordx4 v[36:39], v2, s[32:35], s55 offen offset:32 sc1
    s_add_u32 m0, s63, 0
    s_add_u32 s50, s62, 0
    buffer_load_dwordx4 v14, s[28:31], s50 offen lds
    s_add_u32 m0, s63, 1024
    s_add_u32 s50, s62, 16384
    buffer_load_dwordx4 v14, s[28:31], s50 offen lds
    s_add_u32 m0, s63, 2048
    s_add_u32 s50, s62, 32768
    buffer_load_dwordx4 v14, s[28:31], s50 offen lds
    s_add_u32 m0, s63, 3072
    s_add_u32 s50, s62, 49152
    buffer_load_dwordx4 v14, s[28:31], s50 offen lds
    s_add_u32 m0, s63, 4096
    s_add_u32 s50, s62, 65536
    buffer_load_dwordx4 v14, s[28:31], s50 offen lds
    s_add_u32 m0, s63, 5120
    s_add_u32 s50, s62, 81920
    buffer_load_dwordx4 v14, s[28:31], s50 offen lds
    s_add_u32 m0, s63, 6144
    s_add_u32 s50, s62, 98304
    buffer_load_dwordx4 v14, s[28:31], s50 offen lds
    s_waitcnt vmcnt(6)
    ds_read_b64_tr_b16 v[40:41], v15 offset:0
    ds_read_b64_tr_b16 v[42:43], v15 offset:512
    s_waitcnt vmcnt(5)
    ds_read_b64_tr_b16 v[44:45], v15 offset:1024
    ds_read_b64_tr_b16 v[46:47], v15 offset:1536
    s_waitcnt lgkmcnt(2)
    s_add_u32 m0, s63, 0
    s_add_u32 s50, s62, 114688
    buffer_load_dwordx4 v14, s[28:31], s50 offen lds
    s_waitcnt vmcnt(5)
    ds_read_b64_tr_b16 v[48:49], v15 offset:2048
    ds_read_b64_tr_b16 v[50:51], v15 offset:2560
    s_waitcnt lgkmcnt(2)
    s_add_u32 m0, s63, 1024
    s_add_u32 s50, s62, 131072
    buffer_load_dwordx4 v14, s[28:31], s50 offen lds
    s_waitcnt vmcnt(5)
    ds_read_b64_tr_b16 v[52:53], v15 offset:3072
    ds_read_b64_tr_b16 v[54:55], v15 offset:3584
    s_waitcnt lgkmcnt(2)
    s_add_u32 m0, s63, 2048
    s_add_u32 s50, s62, 147456
    buffer_load_dwordx4 v14, s[28:31], s50 offen lds
    s_waitcnt vmcnt(5)
    ds_read_b64_tr_b16 v[56:57], v15 offset:4096
    ds_read_b64_tr_b16 v[58:59], v15 offset:4608
    s_waitcnt lgkmcnt(2)
    s_add_u32 m0, s63, 3072
    s_add_u32 s50, s62, 163840
    buffer_load_dwordx4 v14, s[28:31], s50 offen lds
    s_waitcnt vmcnt(5)
    ds_read_b64_tr_b16 v[60:61], v15 offset:5120
    ds_read_b64_tr_b16 v[62:63], v15 offset:5632
    s_waitcnt lgkmcnt(2)
    s_add_u32 m0, s63, 4096
    s_add_u32 s50, s62, 180224
    buffer_load_dwordx4 v14, s[28:31], s50 offen lds
    s_waitcnt vmcnt(5)
    ds_read_b64_tr_b16 v[64:65], v15 offset:6144
    ds_read_b64_tr_b16 v[66:67], v15 offset:6656
    s_waitcnt lgkmcnt(2)
    s_add_u32 m0, s63, 5120
    s_add_u32 s50, s62, 196608
    buffer_load_dwordx4 v14, s[28:31], s50 offen lds
    s_waitcnt vmcnt(5)
    ds_read_b64_tr_b16 v[68:69], v15 offset:0
    ds_read_b64_tr_b16 v[70:71], v15 offset:512
    s_waitcnt lgkmcnt(2)
    s_add_u32 m0, s63, 6144
    s_add_u32 s50, s62, 212992
    buffer_load_dwordx4 v14, s[28:31], s50 offen lds
    s_waitcnt vmcnt(5)
    ds_read_b64_tr_b16 v[72:73], v15 offset:1024
    ds_read_b64_tr_b16 v[74:75], v15 offset:1536
    s_waitcnt lgkmcnt(2)
    s_add_u32 m0, s63, 0
    s_add_u32 s50, s62, 229376
    buffer_load_dwordx4 v14, s[28:31], s50 offen lds
    s_waitcnt vmcnt(5)
    ds_read_b64_tr_b16 v[76:77], v15 offset:2048
    ds_read_b64_tr_b16 v[78:79], v15 offset:2560
    s_waitcnt lgkmcnt(2)
    s_add_u32 m0, s63, 1024
    s_add_u32 s50, s62, 245760
    buffer_load_dwordx4 v14, s[28:31], s50 offen lds
    s_waitcnt vmcnt(5)
    ds_read_b64_tr_b16 v[80:81], v15 offset:3072
    ds_read_b64_tr_b16 v[82:83], v15 offset:3584
    s_waitcnt lgkmcnt(2)
    s_add_u32 m0, s63, 2048
    s_add_u32 s50, s62, 262144
    buffer_load_dwordx4 v14, s[28:31], s50 offen lds
    s_waitcnt vmcnt(5)
    ds_read_b64_tr_b16 v[84:85], v15 offset:4096
    ds_read_b64_tr_b16 v[86:87], v15 offset:4608
    s_waitcnt lgkmcnt(2)
    s_add_u32 m0, s63, 3072
    s_add_u32 s50, s62, 278528
    buffer_load_dwordx4 v14, s[28:31], s50 offen lds
    s_waitcnt vmcnt(5)
    ds_read_b64_tr_b16 v[88:89], v15 offset:5120
    ds_read_b64_tr_b16 v[90:91], v15 offset:5632
    s_waitcnt lgkmcnt(2)
    s_add_u32 m0, s63, 4096
    s_add_u32 s50, s62, 294912
    buffer_load_dwordx4 v14, s[28:31], s50 offen lds
    s_waitcnt vmcnt(5)
    ds_read_b64_tr_b16 v[92:93], v15 offset:6144
    ds_read_b64_tr_b16 v[94:95], v15 offset:6656
    s_waitcnt lgkmcnt(2)
    s_add_u32 m0, s63, 5120
    s_add_u32 s50, s62, 311296
    buffer_load_dwordx4 v14, s[28:31], s50 offen lds
    s_waitcnt vmcnt(5)
    ds_read_b64_tr_b16 v[96:97], v15 offset:0
    ds_read_b64_tr_b16 v[98:99], v15 offset:512
    s_waitcnt lgkmcnt(2)
    s_add_u32 m0, s63, 6144
    s_add_u32 s50, s62, 327680
    buffer_load_dwordx4 v14, s[28:31], s50 offen lds
    s_waitcnt vmcnt(5)
    ds_read_b64_tr_b16 v[100:101], v15 offset:1024
    ds_read_b64_tr_b16 v[102:103], v15 offset:1536
    s_waitcnt lgkmcnt(2)
    s_add_u32 m0, s63, 0
    s_add_u32 s50, s62, 344064
    buffer_load_dwordx4 v14, s[28:31], s50 offen lds
    s_waitcnt vmcnt(5)
    ds_read_b64_tr_b16 v[104:105], v15 offset:2048
    ds_read_b64_tr_b16 v[106:107], v15 offset:2560
    s_waitcnt lgkmcnt(2)
    s_add_u32 m0, s63, 1024
    s_add_u32 s50, s62, 360448
    buffer_load_dwordx4 v14, s[28:31], s50 offen lds
    s_waitcnt vmcnt(5)
    ds_read_b64_tr_b16 v[108:109], v15 offset:3072
    ds_read_b64_tr_b16 v[110:111], v15 offset:3584
    s_waitcnt lgkmcnt(2)
    s_add_u32 m0, s63, 2048
    s_add_u32 s50, s62, 376832
    buffer_load_dwordx4 v14, s[28:31], s50 offen lds
    s_waitcnt vmcnt(5)
    ds_read_b64_tr_b16 v[112:113], v15 offset:4096
    ds_read_b64_tr_b16 v[114:115], v15 offset:4608
    s_waitcnt lgkmcnt(2)
    s_add_u32 m0, s63, 3072
    s_add_u32 s50, s62, 393216
    buffer_load_dwordx4 v14, s[28:31], s50 offen lds
    s_waitcnt vmcnt(5)
    ds_read_b64_tr_b16 v[116:117], v15 offset:5120
    ds_read_b64_tr_b16 v[118:119], v15 offset:5632
    s_waitcnt lgkmcnt(2)
    s_add_u32 m0, s63, 4096
    s_add_u32 s50, s62, 409600
    buffer_load_dwordx4 v14, s[28:31], s50 offen lds
    s_waitcnt vmcnt(5)
    ds_read_b64_tr_b16 v[120:121], v15 offset:6144
    ds_read_b64_tr_b16 v[122:123], v15 offset:6656
    s_waitcnt lgkmcnt(2)
    s_add_u32 m0, s63, 5120
    s_add_u32 s50, s62, 425984
    buffer_load_dwordx4 v14, s[28:31], s50 offen lds
    s_waitcnt vmcnt(5)
    ds_read_b64_tr_b16 v[124:125], v15 offset:0
    ds_read_b64_tr_b16 v[126:127], v15 offset:512
    s_waitcnt lgkmcnt(2)
    s_add_u32 m0, s63, 6144
    s_add_u32 s50, s62, 442368
    buffer_load_dwordx4 v14, s[28:31], s50 offen lds
    s_waitcnt vmcnt(5)
    ds_read_b64_tr_b16 v[128:129], v15 offset:1024
    ds_read_b64_tr_b16 v[130:131], v15 offset:1536
    s_waitcnt lgkmcnt(2)
    s_add_u32 m0, s63, 0
    s_add_u32 s50, s62, 458752
    buffer_load_dwordx4 v14, s[28:31], s50 offen lds
    s_waitcnt vmcnt(5)
    ds_read_b64_tr_b16 v[132:133], v15 offset:2048
    ds_read_b64_tr_b16 v[134:135], v15 offset:2560
    s_waitcnt lgkmcnt(2)
    s_add_u32 m0, s63, 1024
    s_add_u32 s50, s62, 475136
    buffer_load_dwordx4 v14, s[28:31], s50 offen lds
    s_waitcnt vmcnt(5)
    ds_read_b64_tr_b16 v[136:137], v15 offset:3072
    ds_read_b64_tr_b16 v[138:139], v15 offset:3584
    s_waitcnt lgkmcnt(2)
    s_add_u32 m0, s63, 2048
    s_add_u32 s50, s62, 491520
    buffer_load_dwordx4 v14, s[28:31], s50 offen lds
    s_waitcnt vmcnt(5)
    ds_read_b64_tr_b16 v[140:141], v15 offset:4096
    ds_read_b64_tr_b16 v[142:143], v15 offset:4608
    s_waitcnt lgkmcnt(2)
    s_add_u32 m0, s63, 3072
    s_add_u32 s50, s62, 507904
    buffer_load_dwordx4 v14, s[28:31], s50 offen lds
    s_waitcnt vmcnt(5)
    ds_read_b64_tr_b16 v[144:145], v15 offset:5120
    ds_read_b64_tr_b16 v[146:147], v15 offset:5632
    s_waitcnt vmcnt(4)
    ds_read_b64_tr_b16 v[148:149], v15 offset:6144
    ds_read_b64_tr_b16 v[150:151], v15 offset:6656
    s_waitcnt vmcnt(3)
    ds_read_b64_tr_b16 v[152:153], v15 offset:0
    ds_read_b64_tr_b16 v[154:155], v15 offset:512
    s_waitcnt vmcnt(2)
    ds_read_b64_tr_b16 v[156:157], v15 offset:1024
    ds_read_b64_tr_b16 v[158:159], v15 offset:1536
    s_waitcnt vmcnt(1)
    ds_read_b64_tr_b16 v[160:161], v15 offset:2048
    ds_read_b64_tr_b16 v[162:163], v15 offset:2560
    s_waitcnt vmcnt(0)
    ds_read_b64_tr_b16 v[164:165], v15 offset:3072
    ds_read_b64_tr_b16 v[166:167], v15 offset:3584
    s_waitcnt lgkmcnt(0)
L_skipA_83:
    s_lshl_b32 s56, s51, 2
    s_add_u32 s56, s56, 30720
    v_mov_b32 v2, s44
    v_mov_b32 v3, s56
    s_mov_b64 exec, 1
    ds_write_b32 v3, v2 offset:32
    s_mov_b64 exec, -1
    v_and_b32 v14, 31, v1
    v_lshlrev_b32 v14, 11, v14
    v_lshrrev_b32 v15, 5, v1
    v_lshlrev_b32 v15, 4, v15
    v_add_u32 v14, v14, v15
    s_lshl_b32 s55, s61, 16
    s_add_u32 s55, s55, s62
    s_add_u32 s55, s55, 1024
    v_lshlrev_b32 v0, 4, v1
    v_add_u32 v15, 32768, v0
    s_lshl_b32 s58, s61, 15
    s_add_u32 s58, s58, 6291456
    s_lshl_b32 s57, s51, 13
    s_add_u32 s58, s58, s57
    s_add_u32 s59, s58, 4096
    s_add_u32 s57, s57, 32768
    v_and_b32 v2, 7, v1
    v_lshlrev_b32 v2, 7, v2
    s_lshl_b32 s56, s61, 12
    s_lshl_b32 s60, s51, 10
    s_add_u32 s56, s56, s60
    s_add_u32 s56, s56, 12713984
    v_and_b32 v13, 3, v1
    v_lshlrev_b32 v13, 2, v13
    v_add_u32 v13, 30848, v13
    s_lshl_b32 s60, s51, 2
    s_add_u32 s60, s60, 30848
    s_barrier
    s_mov_b32 s50, 30000
    buffer_load_dword v3, v2, s[40:43], s56 offen sc1
    s_sleep 6
L_pl_96:
    buffer_load_dword v4, v2, s[40:43], s56 offen sc1
    s_waitcnt vmcnt(1)
    v_cmp_ne_u32 vcc, s44, v3
    s_nop 1
    s_cmp_eq_u64 vcc, 0
    s_cbranch_scc1 L_pld_97
    buffer_load_dword v3, v2, s[40:43], s56 offen sc1
    s_waitcnt vmcnt(1)
    v_cmp_ne_u32 vcc, s44, v4
    s_nop 1
    s_cmp_eq_u64 vcc, 0
    s_cbranch_scc1 L_pld_97
    s_sub_u32 s50, s50, 1
    s_cmp_lg_u32 s50, 0
    s_cbranch_scc1 L_pl_96
L_pld_97:
    s_mov_b32 m0, s57
    s_nop 0
    buffer_load_dwordx4 v0, s[40:43], s58 offen offset:0 sc1 lds
    buffer_load_dwordx4 v0, s[40:43], s58 offen offset:1024 sc1 lds
    buffer_load_dwordx4 v0, s[40:43], s58 offen offset:2048 sc1 lds
    buffer_load_dwordx4 v0, s[40:43], s58 offen offset:3072 sc1 lds
    s_add_u32 m0, s57, 4096
    s_nop 0
    buffer_load_dwordx4 v0, s[40:43], s59 offen offset:0 sc1 lds
    buffer_load_dwordx4 v0, s[40:43], s59 offen offset:1024 sc1 lds
    buffer_load_dwordx4 v0, s[40:43], s59 offen offset:2048 sc1 lds
    buffer_load_dwordx4 v0, s[40:43], s59 offen offset:3072 sc1 lds
    s_mov_b32 s57, 0
    s_waitcnt vmcnt(0)
    v_mov_b32 v10, s44
    v_mov_b32 v11, s60
    s_mov_b64 exec, 1
    ds_write_b32 v11, v10 offset:0
    s_mov_b64 exec, -1
    s_bitcmp1_b32 s57, 0
    s_cbranch_scc1 L_gtd_99
    s_mov_b32 s50, 0x200000
L_gt_98:
    ds_read_b32 v12, v13
    s_waitcnt lgkmcnt(0)
    v_cmp_eq_u32 vcc, s44, v12
    s_nop 1
    s_mov_b32 s57, vcc_lo
    s_bitcmp1_b32 s57, 0
    s_cbranch_scc1 L_gtd_99
    s_sub_u32 s50, s50, 1
    s_cmp_lg_u32 s50, 0
    s_cbranch_scc1 L_gt_98
L_gtd_99:
    ds_read_b128 v[2:5], v15 offset:0
    ds_read_b128 v[6:9], v15 offset:1024
    ds_read_b128 v[32:35], v15 offset:2048
    ds_read_b128 v[36:39], v15 offset:3072
    s_waitcnt lgkmcnt(3)
    v_mfma_f32_32x32x16_bf16 v[16:31], v[40:43], v[2:5], 0
    ds_read_b128 v[2:5], v15 offset:4096
    s_waitcnt lgkmcnt(3)
    v_mfma_f32_32x32x16_bf16 v[16:31], v[44:47], v[6:9], v[16:31]
    ds_read_b128 v[6:9], v15 offset:5120
    s_waitcnt lgkmcnt(3)
    v_mfma_f32_32x32x16_bf16 v[16:31], v[48:51], v[32:35], v[16:31]
    ds_read_b128 v[32:35], v15 offset:6144
    s_waitcnt lgkmcnt(3)
    v_mfma_f32_32x32x16_bf16 v[16:31], v[52:55], v[36:39], v[16:31]
    ds_read_b128 v[36:39], v15 offset:7168
    s_bitcmp1_b32 s57, 1
    s_cbranch_scc1 L_gtd_101
    s_mov_b32 s50, 0x200000
L_gt_100:
    ds_read_b32 v12, v13
    s_waitcnt lgkmcnt(0)
    v_cmp_eq_u32 vcc, s44, v12
    s_nop 1
    s_mov_b32 s57, vcc_lo
    s_bitcmp1_b32 s57, 1
    s_cbranch_scc1 L_gtd_101
    s_sub_u32 s50, s50, 1
    s_cmp_lg_u32 s50, 0
    s_cbranch_scc1 L_gt_100
L_gtd_101:
    s_waitcnt lgkmcnt(3)
    v_mfma_f32_32x32x16_bf16 v[16:31], v[56:59], v[2:5], v[16:31]
    ds_read_b128 v[2:5], v15 offset:8192
    s_waitcnt lgkmcnt(3)
    v_mfma_f32_32x32x16_bf16 v[16:31], v[60:63], v[6:9], v[16:31]
    ds_read_b128 v[6:9], v15 offset:9216
    s_waitcnt lgkmcnt(3)
    v_mfma_f32_32x32x16_bf16 v[16:31], v[64:67], v[32:35], v[16:31]
    ds_read_b128 v[32:35], v15 offset:10240
    s_waitcnt lgkmcnt(3)
    v_mfma_f32_32x32x16_bf16 v[16:31], v[68:71], v[36:39], v[16:31]
    ds_read_b128 v[36:39], v15 offset:11264
    s_waitcnt lgkmcnt(3)
    v_mfma_f32_32x32x16_bf16 v[16:31], v[72:75], v[2:5], v[16:31]
    ds_read_b128 v[2:5], v15 offset:12288
    s_waitcnt lgkmcnt(3)
    v_mfma_f32_32x32x16_bf16 v[16:31], v[76:79], v[6:9], v[16:31]
    ds_read_b128 v[6:9], v15 offset:13312
    s_waitcnt lgkmcnt(3)
    v_mfma_f32_32x32x16_bf16 v[16:31], v[80:83], v[32:35], v[16:31]
    ds_read_b128 v[32:35], v15 offset:14336
    s_waitcnt lgkmcnt(3)
    v_mfma_f32_32x32x16_bf16 v[16:31], v[84:87], v[36:39], v[16:31]
    ds_read_b128 v[36:39], v15 offset:15360
    s_bitcmp1_b32 s57, 2
    s_cbranch_scc1 L_gtd_103
    s_mov_b32 s50, 0x200000
L_gt_102:
    ds_read_b32 v12, v13
    s_waitcnt lgkmcnt(0)
    v_cmp_eq_u32 vcc, s44, v12
    s_nop 1
    s_mov_b32 s57, vcc_lo
    s_bitcmp1_b32 s57, 2
    s_cbranch_scc1 L_gtd_103
    s_sub_u32 s50, s50, 1
    s_cmp_lg_u32 s50, 0
    s_cbranch_scc1 L_gt_102
L_gtd_103:
    s_waitcnt lgkmcnt(3)
    v_mfma_f32_32x32x16_bf16 v[16:31], v[88:91], v[2:5], v[16:31]
    ds_read_b128 v[2:5], v15 offset:16384
    s_waitcnt lgkmcnt(3)
    v_mfma_f32_32x32x16_bf16 v[16:31], v[92:95], v[6:9], v[16:31]
    ds_read_b128 v[6:9], v15 offset:17408
    s_waitcnt lgkmcnt(3)
    v_mfma_f32_32x32x16_bf16 v[16:31], v[96:99], v[32:35], v[16:31]
    ds_read_b128 v[32:35], v15 offset:18432
    s_waitcnt lgkmcnt(3)
    v_mfma_f32_32x32x16_bf16 v[16:31], v[100:103], v[36:39], v[16:31]
    ds_read_b128 v[36:39], v15 offset:19456
    s_waitcnt lgkmcnt(3)
    v_mfma_f32_32x32x16_bf16 v[16:31], v[104:107], v[2:5], v[16:31]
    ds_read_b128 v[2:5], v15 offset:20480
    s_waitcnt lgkmcnt(3)
    v_mfma_f32_32x32x16_bf16 v[16:31], v[108:111], v[6:9], v[16:31]
    ds_read_b128 v[6:9], v15 offset:21504
    s_waitcnt lgkmcnt(3)
    v_mfma_f32_32x32x16_bf16 v[16:31], v[112:115], v[32:35], v[16:31]
    ds_read_b128 v[32:35], v15 offset:22528
    s_waitcnt lgkmcnt(3)
    v_mfma_f32_32x32x16_bf16 v[16:31], v[116:119], v[36:39], v[16:31]
    ds_read_b128 v[36:39], v15 offset:23552
    s_bitcmp1_b32 s57, 3
    s_cbranch_scc1 L_gtd_105
    s_mov_b32 s50, 0x200000
L_gt_104:
    ds_read_b32 v12, v13
    s_waitcnt lgkmcnt(0)
    v_cmp_eq_u32 vcc, s44, v12
    s_nop 1
    s_mov_b32 s57, vcc_lo
    s_bitcmp1_b32 s57, 3
    s_cbranch_scc1 L_gtd_105
    s_sub_u32 s50, s50, 1
    s_cmp_lg_u32 s50, 0
    s_cbranch_scc1 L_gt_104
L_gtd_105:
    s_waitcnt lgkmcnt(3)
    v_mfma_f32_32x32x16_bf16 v[16:31], v[120:123], v[2:5], v[16:31]
    ds_read_b128 v[2:5], v15 offset:24576
    s_waitcnt lgkmcnt(3)
    v_mfma_f32_32x32x16_bf16 v[16:31], v[124:127], v[6:9], v[16:31]
    ds_read_b128 v[6:9], v15 offset:25600
    s_waitcnt lgkmcnt(3)
    v_mfma_f32_32x32x16_bf16 v[16:31], v[128:131], v[32:35], v[16:31]
    ds_read_b128 v[32:35], v15 offset:26624
    s_waitcnt lgkmcnt(3)
    v_mfma_f32_32x32x16_bf16 v[16:31], v[132:135], v[36:39], v[16:31]
    ds_read_b128 v[36:39], v15 offset:27648
    s_waitcnt lgkmcnt(3)
    v_mfma_f32_32x32x16_bf16 v[16:31], v[136:139], v[2:5], v[16:31]
    ds_read_b128 v[2:5], v15 offset:28672
    s_waitcnt lgkmcnt(3)
    v_mfma_f32_32x32x16_bf16 v[16:31], v[140:143], v[6:9], v[16:31]
    ds_read_b128 v[6:9], v15 offset:29696
    s_waitcnt lgkmcnt(3)
    v_mfma_f32_32x32x16_bf16 v[16:31], v[144:147], v[32:35], v[16:31]
    ds_read_b128 v[32:35], v15 offset:30720
    s_waitcnt lgkmcnt(3)
    v_mfma_f32_32x32x16_bf16 v[16:31], v[148:151], v[36:39], v[16:31]
    ds_read_b128 v[36:39], v15 offset:31744
    s_waitcnt lgkmcnt(3)
    v_mfma_f32_32x32x16_bf16 v[16:31], v[152:155], v[2:5], v[16:31]
    s_waitcnt lgkmcnt(2)
    v_mfma_f32_32x32x16_bf16 v[16:31], v[156:159], v[6:9], v[16:31]
    s_waitcnt lgkmcnt(1)
    v_mfma_f32_32x32x16_bf16 v[16:31], v[160:163], v[32:35], v[16:31]
    s_waitcnt lgkmcnt(0)
    v_mfma_f32_32x32x16_bf16 v[16:31], v[164:167], v[36:39], v[16:31]
    s_nop 11
    v_cvt_pk_bf16_f32 v32, v16, v17
    v_cvt_pk_bf16_f32 v33, v18, v19
    v_cvt_pk_bf16_f32 v34, v20, v21
    v_cvt_pk_bf16_f32 v35, v22, v23
    v_cvt_pk_bf16_f32 v36, v24, v25
    v_cvt_pk_bf16_f32 v37, v26, v27
    v_cvt_pk_bf16_f32 v38, v28, v29
    v_cvt_pk_bf16_f32 v39, v30, v31
    s_nop 1
    v_permlane32_swap_b32 v32, v34
    v_permlane32_swap_b32 v33, v35
    v_permlane32_swap_b32 v36, v38
    v_permlane32_swap_b32 v37, v39
    buffer_store_dwordx4 v[32:35], v14, s[32:35], s55 offen
    buffer_store_dwordx4 v[36:39], v14, s[32:35], s55 offen offset:32
    s_endpgm
L_exit:
    s_endpgm
.section .rodata,"a"
.p2align 6
.amdhsa_kernel concat_heads__sliding_local_dilated__softmax_full_mha__prompt_kernel
  .amdhsa_next_free_vgpr 168
  .amdhsa_next_free_sgpr 98
  .amdhsa_accum_offset 168
  .amdhsa_group_segment_fixed_size 0
  .amdhsa_kernarg_size 72
  .amdhsa_user_sgpr_count 2
  .amdhsa_user_sgpr_kernarg_segment_ptr 1
  .amdhsa_system_sgpr_workgroup_id_x 1
.end_amdhsa_kernel
```
